```python
import torch

def _softmax(x, axis=-1):
    return torch.softmax(x, dim=axis)

def _gelu(x):
    return torch.nn.functional.gelu(x, approximate='tanh')

def _silu(x):
    return torch.nn.functional.silu(x)

def _sigmoid(x):
    return torch.sigmoid(x)

def _layernorm(x, axis=-1, eps=1e-05):
    m = x.mean(dim=axis, keepdim=True)
    v = x.var(dim=axis, keepdim=True, unbiased=False)
    return (x - m) / torch.sqrt(v + eps)

def _scatter_add(tgt, idx, src, axis=0):
    return tgt.clone().index_add_(axis, idx, src)

def _segment_sum(src, seg, n):
    out = torch.zeros((n,) + src.shape[1:], dtype=src.dtype)
    return out.index_add_(0, seg, src)

def _pad(x, pw):
    flat = tuple((v for pair in reversed(pw) for v in pair))
    return torch.nn.functional.pad(x, flat)
kernel_name = 'adaLN_cond__sliding_local_dilated__mixer_channel_mlp__prompt'

def setup_inputs():

    _w = lambda a: (lambda t: t.to(torch.bfloat16) if t.is_floating_point() else t)(torch.as_tensor(a))

    def _A_setup():
        B, S, D = (1, 2048, 512)
        return {'x': _w((lambda *s: torch.randn(*s, dtype=torch.bfloat16) * 0.05)(B, S, D)), 'wqkv': _w((lambda *s: torch.randn(*s, dtype=torch.bfloat16) * 0.05)(D, 3 * D)), 'wo': _w((lambda *s: torch.randn(*s, dtype=torch.bfloat16) * 0.05)(D, D))}
    _A_in = _A_setup()

    def _B_setup():
        B, S, D, F = (1, 2048, 512, 1376)
        return {'x': _w((lambda *s: torch.randn(*s, dtype=torch.bfloat16) * 0.05)(B, S, D)), 'w1': _w((lambda *s: torch.randn(*s, dtype=torch.bfloat16) * 3.2)(D, F) * D ** (-0.5)), 'b1': _w((lambda *s: torch.randn(*s, dtype=torch.bfloat16) * 1.6)(F)), 'w2': _w((lambda *s: torch.randn(*s, dtype=torch.bfloat16) * 1.6)(F, D) * F ** (-0.5)), 'b2': _w((lambda *s: torch.randn(*s, dtype=torch.bfloat16) * 1.6)(D))}
    _B_in = _B_setup()
    return {'A_x': _A_in['x'], 'A_wqkv': _A_in['wqkv'], 'A_wo': _A_in['wo'], 'B_x': _B_in['x'], 'B_w1': _B_in['w1'], 'B_b1': _B_in['b1'], 'B_w2': _B_in['w2'], 'B_b2': _B_in['b2'], 'c': _w((lambda *s: torch.randn(*s, dtype=torch.bfloat16) * 0.2)(1, 512) * 8.0), 'w_mod': _w((lambda *s: torch.randn(*s, dtype=torch.bfloat16) * 0.2)(512, 6 * 512) * 512 ** (-0.5) * 8.0)}

def reference(A_x, A_wqkv, A_wo, B_x, B_w1, B_b1, B_w2, B_b2, c, w_mod):

    def _A_ref(x, wqkv, wo):
        B, S, D = x.shape
        H = 32
        Dh = D // H
        W, dil = (8, 2)
        qkv = (lambda x, *d: x.permute(*d))((x @ wqkv).reshape(B, S, 3, H, Dh), 2, 0, 3, 1, 4)
        q, k, v = (qkv[0], qkv[1], qkv[2])
        scale = Dh ** (-0.5)
        pos = torch.arange(S)
        off = torch.arange(W) * dil
        idx = pos[:, None] - off[None, :]
        mask = idx >= 0
        idx_c = torch.where(mask, idx, 0).reshape(-1)
        kg = k[:, :, idx_c, :].reshape(B, H, S, W, Dh)
        vg = v[:, :, idx_c, :].reshape(B, H, S, W, Dh)
        logits = torch.einsum('bhsd,bhswd->bhsw', q, kg) * scale
        logits = torch.where(mask[None, None, :, :], logits, -1000000000.0)
        attn = _softmax(logits, axis=-1)
        o = torch.einsum('bhsw,bhswd->bhsd', attn, vg)
        return (lambda x, *d: x.permute(*d))(o, 0, 2, 1, 3).reshape(B, S, D) @ wo

    def _B_ref(x, w1, b1, w2, b2):
        y = _layernorm(x, axis=-1)
        h = _gelu(torch.einsum('bsd,df->bsf', y, w1) + b1)
        return torch.einsum('bsf,fd->bsd', h, w2) + b2
    x = A_x
    mod = (_silu(c) @ w_mod).reshape(c.shape[0], 6, 1, -1)
    sa, ca, ga, sb, cb, gb = (mod[:, 0].clone(), mod[:, 1].clone(), mod[:, 2].clone(), mod[:, 3].clone(), mod[:, 4].clone(), mod[:, 5].clone())
    h = _layernorm(x, axis=-1) * (1 + ca) + sa
    x = x + ga * _A_ref(h, A_wqkv, A_wo)
    h = _layernorm(x, axis=-1) * (1 + cb) + sb
    x = x + gb * _B_ref(h, B_w1, B_b1, B_w2, B_b2)
    return x
```

```asm
; @launch grid=(256,1,1) block=(256,1,1) lds=163840
.amdgcn_target "amdgcn-amd-amdhsa--gfx950"
.text
.globl adaLN_cond__sliding_local_dilated__mixer_channel_mlp__prompt_kernel
.p2align 8
.type adaLN_cond__sliding_local_dilated__mixer_channel_mlp__prompt_kernel,@function
adaLN_cond__sliding_local_dilated__mixer_channel_mlp__prompt_kernel:
    s_cmp_lt_u32 s2, 256
    s_cbranch_scc1 L_go
    s_endpgm
L_go:
    s_load_dwordx16 s[4:19], s[0:1], 0
    s_load_dwordx8 s[20:27], s[0:1], 64
    s_load_dwordx2 s[28:29], s[0:1], 96
    s_getpc_b64 s[30:31]
    v_lshrrev_b32 v25, 6, v0
    v_and_b32 v0, 63, v0
    v_readfirstlane_b32 s3, v25
    s_bfe_u32 s65, s2, 0x30003
    s_lshl_b32 s71, s65, 2
    s_add_u32 s71, s71, s3
    s_mul_i32 s69, s71, 1024
    v_lshlrev_b32 v4, 7, v0
    v_add_u32 v25, s69, v4
    s_mov_b64 exec, 0x000000ff
    global_load_dword v5, v25, s[30:31]
    s_mov_b64 exec, -1
    v_lshlrev_b32 v1, 4, v0
    s_and_b32 s69, s2, 7
    s_lshr_b32 s101, s2, 6
    s_lshl_b32 s64, s69, 2
    s_add_u32 s64, s64, s101
    s_lshl_b32 s68, s64, 6
    s_lshr_b32 s92, s2, 3
    s_lshl_b32 s92, s92, 2
    s_add_u32 s92, s92, s3
    v_lshrrev_b32 v27, 2, v0
    v_mul_u32_u24 v91, 6144, v27
    v_and_b32 v27, 3, v0
    v_lshl_add_u32 v91, v27, 7, v91
    s_mul_i32 s73, s92, 24576
    s_lshl_b32 s70, s69, 9
    s_add_u32 s93, s73, s70
    s_lshl_b32 s70, s69, 8
    s_add_u32 s73, s73, s70
    s_mul_i32 s80, s65, 10
    s_add_u32 s80, s80, s3
    s_add_u32 s81, s80, 4
    s_add_u32 s82, s80, 8
    s_min_u32 s82, s82, 79
    s_add_u32 s76, s80, s68
    s_sub_u32 s76, s76, 16
    s_max_i32 s76, s76, 0
    s_lshl_b32 s76, s76, 10
    s_add_u32 s77, s81, s68
    s_sub_u32 s77, s77, 16
    s_max_i32 s77, s77, 0
    s_lshl_b32 s77, s77, 10
    s_add_u32 s78, s82, s68
    s_sub_u32 s78, s78, 16
    s_max_i32 s78, s78, 0
    s_lshl_b32 s78, s78, 10
    s_lshl_b32 s100, s69, 3
    s_min_u32 s70, s101, 2
    s_lshl_b32 s70, s70, 3
    s_add_u32 s70, s70, 56
    s_add_u32 s70, s70, s100
    s_cmp_eq_u32 s101, 0
    s_cselect_b32 s70, 0, s70
    s_add_u32 s100, s100, s70
    s_add_u32 s100, s100, s65
    s_lshl_b32 s94, s2, 2
    s_add_u32 s94, s94, s3
    s_mul_i32 s70, s94, 1536
    v_add_u32 v90, s70, v4
    s_mul_i32 s70, s92, 12288
    s_add_u32 s70, s70, 0xffffd180
    v_lshl_add_u32 v27, v0, 10, s70
    v_cmp_lt_u32 vcc, 11, v0
    v_lshrrev_b32 v26, 1, v0
    s_lshl_b32 s69, s3, 8
    v_cndmask_b32 v90, v90, v27, vcc
    v_mul_u32_u24 v58, 24576, v26
    v_lshl_add_u32 v26, v26, 3, s69
    v_mov_b32 v28, 0
    s_waitcnt lgkmcnt(0)
    s_mov_b64 s[0:1], s[30:31]
    s_mov_b32 s60, s22
    s_mov_b32 s61, s23
    s_mov_b32 s62, 0x00300000
    s_mov_b32 s63, 0x00020000
    s_mov_b64 exec, 0x3333
    buffer_load_dword v5, v91, s[60:63], s73 offen
    s_mov_b64 exec, -1
    s_mov_b32 s52, s28
    s_mov_b32 s53, s29
    s_mov_b32 s54, 0x00a00000
    s_mov_b32 s55, 0x00020000
    buffer_load_dword v29, v28, s[52:55], 0 offen sc1
    global_load_dwordx2 v[62:63], v26, s[20:21]
    s_mov_b32 s36, s6
    s_mov_b32 s37, s7
    s_mov_b32 s38, 0x00180000
    s_mov_b32 s39, 0x00020000
    s_mov_b64 exec, 0xffffff
    buffer_load_dword v5, v90, s[36:39], 0 offen
    s_mov_b64 exec, -1
    s_mov_b32 s40, s8
    s_mov_b32 s41, s9
    s_mov_b32 s42, 0x00080000
    s_mov_b32 s43, 0x00020000
    s_lshl_b32 s69, s94, 9
    v_add_u32 v90, s69, v4
    s_lshl_b32 s69, s92, 12
    s_add_u32 s69, s69, 0xfffff180
    v_lshl_add_u32 v27, v0, 10, s69
    v_cmp_lt_u32 vcc, 3, v0
    s_nop 1
    v_cndmask_b32 v90, v90, v27, vcc
    s_mov_b64 exec, 0xff
    buffer_load_dword v5, v90, s[40:43], 0 offen
    s_mov_b64 exec, -1
    s_mov_b32 s32, s4
    s_mov_b32 s33, s5
    s_mov_b32 s34, 0x00200000
    s_mov_b32 s35, 0x00020000
    s_mov_b32 s44, s12
    s_mov_b32 s45, s13
    s_mov_b32 s46, 0x00158000
    s_mov_b32 s47, 0x00020000
    s_mov_b32 s48, s16
    s_mov_b32 s49, s17
    s_mov_b32 s50, 0x00158000
    s_mov_b32 s51, 0x00020000
    s_mov_b32 s56, s24
    s_mov_b32 s57, s25
    s_mov_b32 s58, 0x00200000
    s_mov_b32 s59, 0x00020000
    s_mov_b32 s85, 0
    s_mul_i32 s86, s64, 294912
    s_add_u32 s86, s86, 1048576
    s_getreg_b32 s26, hwreg(HW_REG_XCC_ID)
    s_and_b32 s26, s26, 15
    s_mul_i32 s27, s3, 786432
    s_lshl_b32 s70, s100, 5
    s_add_u32 s27, s27, s70
    v_and_b32 v28, 1, v0
    v_lshl_add_u32 v58, v28, 4, v58
    v_and_b32 v23, 15, v0
    v_lshrrev_b32 v24, 4, v0
    v_lshrrev_b32 v25, 1, v24
    v_and_b32 v26, 1, v24
    v_lshl_add_u32 v27, v26, 1, v25
    v_lshl_add_u32 v27, v28, 3, v27
    s_lshl_b32 s69, s3, 6
    s_add_u32 s69, s69, 162816
    v_lshl_add_u32 v59, v27, 2, s69
    v_and_b32 v28, 7, v0
    v_lshlrev_b32 v39, 2, v28
    v_lshlrev_b32 v28, 4, v28
    v_lshlrev_b32 v27, 5, v26
    v_xor_b32 v28, v28, v27
    v_lshrrev_b32 v95, 3, v0
    s_and_b32 s71, s3, 1
    s_lshl_b32 s71, s71, 6
    v_xor_b32 v26, s71, v28
    v_mul_u32_u24 v2, 3072, v95
    v_add_u32 v2, v2, v26
    s_mul_i32 s87, s3, 24576
    s_lshl_b32 s69, s65, 7
    s_add_u32 s87, s87, s69
    s_mul_i32 s88, s3, 3072
    s_sub_u32 s70, s101, 1
    s_cmp_gt_u32 s70, 1
    s_cbranch_scc1 Lnt_1
    s_and_b32 s91, s100, 3
    s_mul_i32 s91, s91, 6144
    s_add_u32 s91, s91, s27
    buffer_load_dword v5, v58, s[60:63], s91 offen
Lnt_1:
    v_lshl_add_u32 v6, v95, 10, v28
    v_xor_b32 v7, 64, v6
    v_add_u32 v7, 7168, v7
    v_add_u32 v8, 14336, v6
    v_add_u32 v9, 14336, v7
    v_lshl_add_u32 v32, v95, 10, v26
    s_lshl_b32 s89, s3, 13
    s_add_u32 s89, s89, s69
    s_lshl_b32 s90, s3, 10
    s_lshl_b32 s25, s3, 12
    v_mov_b32 v47, 0x3f803f80
    v_bfe_u32 v92, v0, 2, 2
    v_lshrrev_b32 v26, 1, v92
    v_and_b32 v27, 1, v24
    v_lshl_add_u32 v94, v27, 1, v26
    v_and_b32 v93, 3, v0
    v_lshlrev_b32 v93, 3, v93
    v_mul_u32_u24 v27, 3072, v24
    v_lshl_add_u32 v27, v92, 7, v27
    v_add_u32 v27, v27, v93
    v_xor_b32 v26, s3, v94
    v_lshl_add_u32 v3, v26, 5, v27
    v_add_u32 v18, 81920, v3
    v_lshl_add_u32 v28, v24, 3, v92
    v_lshl_add_u32 v27, v28, 7, v93
    v_add_u32 v27, 81920, v27
    s_add_u32 s70, s3, 0
    s_and_b32 s70, s70, 3
    v_xor_b32 v26, s70, v94
    v_lshl_add_u32 v19, v26, 5, v27
    s_add_u32 s70, s3, 1
    s_and_b32 s70, s70, 3
    v_xor_b32 v26, s70, v94
    v_lshl_add_u32 v20, v26, 5, v27
    s_add_u32 s70, s3, 2
    s_and_b32 s70, s70, 3
    v_xor_b32 v26, s70, v94
    v_lshl_add_u32 v21, v26, 5, v27
    s_add_u32 s70, s3, 3
    s_and_b32 s70, s70, 3
    v_xor_b32 v26, s70, v94
    v_lshl_add_u32 v22, v26, 5, v27
    v_mul_u32_u24 v25, 384, v28
    v_add_u32 v25, v25, v93
    v_add_u32 v25, 81920, v25
    s_mul_i32 s70, s3, 3
    s_mul_i32 s98, s65, 12
    s_min_u32 s98, s98, 74
    s_mul_i32 s22, s3, 22016
    s_lshl_b32 s69, s98, 5
    s_add_u32 s22, s22, s69
    s_add_u32 s98, s98, s70
    s_lshl_b32 s95, s98, 5
    s_lshl_b32 s98, s98, 9
    s_add_u32 s98, s98, s86
    v_xor_b32 v26, s70, v94
    v_lshl_add_u32 v34, v26, 5, v25
    s_add_u32 s70, s70, 1
    v_xor_b32 v26, s70, v94
    v_lshl_add_u32 v35, v26, 5, v25
    s_add_u32 s70, s70, 1
    v_xor_b32 v26, s70, v94
    v_lshl_add_u32 v36, v26, 5, v25
    s_and_b32 s69, s80, 15
    s_lshl_b32 s70, s80, 10
    v_xor_b32 v25, s69, v0
    v_lshl_add_u32 v164, v25, 4, s70
    s_and_b32 s69, s81, 15
    s_lshl_b32 s70, s81, 10
    v_xor_b32 v25, s69, v0
    v_lshl_add_u32 v165, v25, 4, s70
    s_and_b32 s69, s82, 15
    s_lshl_b32 s70, s82, 10
    s_cmp_lt_u32 s3, 2
    s_cselect_b32 s70, s70, 0x7ff00000
    v_xor_b32 v25, s69, v0
    v_lshl_add_u32 v166, v25, 4, s70
    v_lshlrev_b32 v26, 10, v23
    v_add_u32 v25, 0, v24
    v_xor_b32 v25, v25, v23
    v_lshl_add_u32 v14, v25, 4, v26
    v_add_u32 v10, 0x10000, v14
    v_add_u32 v25, 4, v24
    v_xor_b32 v25, v25, v23
    v_lshl_add_u32 v15, v25, 4, v26
    v_add_u32 v11, 0x10000, v15
    v_add_u32 v25, 8, v24
    v_xor_b32 v25, v25, v23
    v_lshl_add_u32 v16, v25, 4, v26
    v_add_u32 v12, 0x10000, v16
    v_add_u32 v25, 12, v24
    v_xor_b32 v25, v25, v23
    v_lshl_add_u32 v17, v25, 4, v26
    v_add_u32 v13, 0x10000, v17
    v_add_u32 v25, 0, v0
    v_mul_u32_u24 v26, 2731, v25
    v_lshrrev_b32 v26, 16, v26
    v_mul_u32_u24 v27, 24, v26
    v_sub_u32 v27, v25, v27
    v_lshlrev_b32 v27, 4, v27
    v_bfe_u32 v28, v26, 1, 1
    v_lshlrev_b32 v28, 5, v28
    v_xor_b32 v27, v27, v28
    v_xor_b32 v27, s71, v27
    v_mul_u32_u24 v26, 2752, v26
    v_add_u32 v52, v26, v27
    v_add_u32 v25, 64, v0
    v_mul_u32_u24 v26, 2731, v25
    v_lshrrev_b32 v26, 16, v26
    v_mul_u32_u24 v27, 24, v26
    v_sub_u32 v27, v25, v27
    v_lshlrev_b32 v27, 4, v27
    v_bfe_u32 v28, v26, 1, 1
    v_lshlrev_b32 v28, 5, v28
    v_xor_b32 v27, v27, v28
    v_xor_b32 v27, s71, v27
    v_mul_u32_u24 v26, 2752, v26
    v_add_u32 v53, v26, v27
    v_subrev_u32 v53, 1024, v53
    v_add_u32 v25, 128, v0
    v_mul_u32_u24 v26, 2731, v25
    v_lshrrev_b32 v26, 16, v26
    v_mul_u32_u24 v27, 24, v26
    v_sub_u32 v27, v25, v27
    v_lshlrev_b32 v27, 4, v27
    v_bfe_u32 v28, v26, 1, 1
    v_lshlrev_b32 v28, 5, v28
    v_xor_b32 v27, v27, v28
    v_xor_b32 v27, s71, v27
    v_mul_u32_u24 v26, 2752, v26
    v_add_u32 v54, v26, v27
    v_subrev_u32 v54, 2048, v54
    s_cmp_eq_u32 s3, 3
    s_cselect_b32 s69, 0x7ffffff0, 0
    v_or_b32 v46, s69, v1
    s_mov_b32 s99, 0x7f800000
    s_cmp_eq_u32 s64, 0
    s_cselect_b32 s99, 0xcf6e6b28, s99
    v_lshlrev_b32 v25, 2, v24
    v_add_u32 v26, 0, v25
    v_cmp_le_u32 s[4:5], v26, v23
    v_add_u32 v26, 1, v25
    v_cmp_le_u32 s[6:7], v26, v23
    v_add_u32 v26, 2, v25
    v_cmp_le_u32 s[8:9], v26, v23
    v_add_u32 v26, 3, v25
    v_cmp_le_u32 s[10:11], v26, v23
    v_and_b32 v26, 1, v23
    v_cmp_eq_u32 s[12:13], 1, v26
    v_mov_b32 v27, 0xffff
    v_mov_b32 v28, 0xffff0000
    v_cndmask_b32 v27, v27, v28, s[12:13]
    v_add_u32 v26, v26, v25
    v_cmp_le_u32 vcc, v26, v23
    s_nop 1
    v_cndmask_b32 v50, 0, v27, vcc
    v_xor_b32 v48, v50, v27
    v_add_u32 v26, 2, v26
    v_cmp_le_u32 vcc, v26, v23
    s_nop 1
    v_cndmask_b32 v51, 0, v27, vcc
    v_xor_b32 v49, v51, v27
    v_lshrrev_b32 v25, 1, v24
    v_and_b32 v26, 1, v24
    v_lshlrev_b32 v25, 8, v25
    v_lshl_add_u32 v25, v23, 4, v25
    v_lshl_add_u32 v37, v26, 14, v25
    v_mul_u32_u24 v26, 44032, v26
    v_add_u32 v38, v26, v25
    s_lshl_b32 s16, s65, 11
    s_lshl_b32 s70, s3, 9
    s_add_u32 s16, s16, s70
    s_add_u32 s16, s16, s86
    s_add_u32 s17, s86, 266240
    s_lshl_b32 s69, s65, 2
    v_mov_b32 v41, s69
    s_lshl_b32 s69, s65, 7
    s_lshl_b32 s70, s3, 5
    s_add_u32 s69, s69, s70
    s_lshl_b32 s96, s68, 10
    s_add_u32 s96, s96, s69
    s_add_u32 s69, s69, 145408
    v_lshl_add_u32 v42, v24, 3, s69
    v_lshlrev_b32 v43, 3, v0
    s_lshl_b32 s97, s3, 8
    s_add_u32 s97, s97, s86
    s_add_u32 s97, s97, 241664
    v_mul_u32_u24 v45, 6144, v24
    v_lshl_add_u32 v45, v23, 4, v45
    v_lshrrev_b32 v25, 2, v23
    v_mov_b32 v44, 151552
    v_mov_b32 v27, 149504
    v_cmp_eq_u32 vcc, 0, v25
    s_nop 1
    v_cndmask_b32 v44, v44, v27, vcc
    v_mov_b32 v27, 148480
    v_cmp_eq_u32 vcc, 1, v25
    s_nop 1
    v_cndmask_b32 v44, v44, v27, vcc
    v_lshl_add_u32 v44, v24, 4, v44
    s_lshl_b32 s24, s64, 7
    s_add_u32 s24, s24, 32768
    s_lshl_b32 s23, s3, 11
    s_add_u32 s23, s23, 12288
    v_and_b32 v25, 7, v0
    v_lshlrev_b32 v25, 4, v25
    v_lshl_add_u32 v250, v95, 10, v25
    v_add_u32 v254, 8192, v250
    s_lshl_b32 s93, s3, 4
    s_add_u32 s93, s93, s68
    s_lshl_b32 s93, s93, 10
    s_lshl_b32 s69, s65, 7
    s_add_u32 s93, s93, s69
    s_lshl_b32 s69, s3, 5
    s_add_u32 s69, s69, 152576
    v_lshl_add_u32 v25, v23, 7, s69
    v_lshl_add_u32 v33, v24, 3, v25
    s_mul_i32 s69, s94, 1408
    v_min_u32 v25, 1280, v4
    v_add_u32 v251, s69, v25
    v_lshl_add_u32 v252, v23, 1, s95
    s_lshl_b32 s69, s65, 7
    v_min_u32 v25, 31, v0
    v_lshl_add_u32 v253, v25, 2, s69
    s_mul_i32 s69, s92, 11264
    s_add_u32 s69, s69, 0xffffd580
    v_min_u32 v25, 21, v0
    v_lshl_add_u32 v25, v25, 10, s69
    v_cmp_lt_u32 vcc, 10, v0
    s_nop 1
    v_cndmask_b32 v178, v251, v25, vcc
    v_mov_b32 v180, 0x3f803f80
    v_mov_b32 v181, 0x3f803f80
    v_mov_b32 v182, 0x3f803f80
    v_mov_b32 v183, 0x3f803f80
    v_add_u32 v26, 151552, v1
    ds_write_b128 v26, v[180:183]
    s_cmp_eq_u32 s101, 3
    s_cbranch_scc1 Lnw_2
    s_add_u32 s91, s27, 0
    buffer_load_dwordx4 v[96:99], v58, s[60:63], s91 offen
    s_add_u32 s91, s27, 6144
    buffer_load_dwordx4 v[100:103], v58, s[60:63], s91 offen
    s_add_u32 s91, s27, 12288
    buffer_load_dwordx4 v[104:107], v58, s[60:63], s91 offen
    s_add_u32 s91, s27, 18432
    buffer_load_dwordx4 v[108:111], v58, s[60:63], s91 offen
Lnw_2:
    s_add_u32 m0, s90, 0
    s_add_u32 s91, s89, 0
    buffer_load_dwordx4 v32, s[40:43], s91 offen lds
    s_add_u32 m0, s90, 4096
    s_add_u32 s91, s89, 32768
    buffer_load_dwordx4 v32, s[40:43], s91 offen lds
    s_waitcnt vmcnt(4)
    v_readfirstlane_b32 s66, v29
    s_nop 0
    s_mul_i32 s66, s66, 1664525
    s_add_u32 s66, s66, 1013904223
    s_cmp_lg_u32 s3, 3
    s_cbranch_scc1 Lxe_3
    v_mov_b32 v27, s66
    v_mov_b32 v26, s26
    v_lshlrev_b32 v25, 1, v41
    s_mov_b64 exec, 1
    buffer_store_dwordx2 v[26:27], v25, s[52:55], s24 offen sc1
    s_mov_b64 exec, -1
Lxe_3:
    v_lshlrev_b32 v60, 16, v62
    v_and_b32 v61, 0xffff0000, v62
    v_lshlrev_b32 v62, 16, v63
    v_and_b32 v63, 0xffff0000, v63
    v_mul_f32 v88, 0xbfb8aa3b, v60
    v_mul_f32 v89, 0xbfb8aa3b, v61
    v_mul_f32 v90, 0xbfb8aa3b, v62
    v_mul_f32 v91, 0xbfb8aa3b, v63
    v_exp_f32 v88, v88
    v_exp_f32 v89, v89
    v_exp_f32 v90, v90
    v_exp_f32 v91, v91
    v_add_f32 v88, 1.0, v88
    v_add_f32 v89, 1.0, v89
    v_add_f32 v90, 1.0, v90
    v_add_f32 v91, 1.0, v91
    v_rcp_f32 v88, v88
    v_rcp_f32 v89, v89
    v_rcp_f32 v90, v90
    v_rcp_f32 v91, v91
    v_mul_f32 v60, v60, v88
    v_mul_f32 v61, v61, v89
    v_mul_f32 v62, v62, v90
    v_mul_f32 v63, v63, v91
    v_cvt_pk_bf16_f32 v88, v60, v61
    v_cvt_pk_bf16_f32 v89, v62, v63
    v_lshlrev_b32 v60, 16, v88
    v_and_b32 v61, 0xffff0000, v88
    v_lshlrev_b32 v62, 16, v89
    v_and_b32 v63, 0xffff0000, v89
    s_cmp_eq_u32 s101, 3
    s_cbranch_scc1 Lp0e_4
    s_waitcnt vmcnt(2)
    v_lshlrev_b32 v120, 16, v96
    v_and_b32 v121, 0xffff0000, v96
    v_lshlrev_b32 v122, 16, v97
    v_and_b32 v123, 0xffff0000, v97
    v_lshlrev_b32 v124, 16, v98
    v_and_b32 v125, 0xffff0000, v98
    v_lshlrev_b32 v126, 16, v99
    v_and_b32 v127, 0xffff0000, v99
    v_pk_mul_f32 v[112:113], v[120:121], v[60:61] op_sel_hi:[1,0]
    v_pk_mul_f32 v[114:115], v[122:123], v[60:61] op_sel_hi:[1,0]
    v_pk_mul_f32 v[116:117], v[124:125], v[60:61] op_sel_hi:[1,0]
    v_pk_mul_f32 v[118:119], v[126:127], v[60:61] op_sel_hi:[1,0]
    v_lshlrev_b32 v120, 16, v100
    v_and_b32 v121, 0xffff0000, v100
    v_lshlrev_b32 v122, 16, v101
    s_add_u32 m0, s90, 8192
    s_add_u32 s91, s89, 65536
    buffer_load_dwordx4 v32, s[40:43], s91 offen lds
    v_and_b32 v123, 0xffff0000, v101
    v_lshlrev_b32 v124, 16, v102
    v_and_b32 v125, 0xffff0000, v102
    v_lshlrev_b32 v126, 16, v103
    v_and_b32 v127, 0xffff0000, v103
    v_pk_fma_f32 v[112:113], v[120:121], v[60:61], v[112:113] op_sel:[0,1,0] op_sel_hi:[1,1,1]
    v_pk_fma_f32 v[114:115], v[122:123], v[60:61], v[114:115] op_sel:[0,1,0] op_sel_hi:[1,1,1]
    v_pk_fma_f32 v[116:117], v[124:125], v[60:61], v[116:117] op_sel:[0,1,0] op_sel_hi:[1,1,1]
    v_pk_fma_f32 v[118:119], v[126:127], v[60:61], v[118:119] op_sel:[0,1,0] op_sel_hi:[1,1,1]
    v_lshlrev_b32 v120, 16, v104
    v_and_b32 v121, 0xffff0000, v104
    v_lshlrev_b32 v122, 16, v105
    v_and_b32 v123, 0xffff0000, v105
    v_lshlrev_b32 v124, 16, v106
    v_and_b32 v125, 0xffff0000, v106
    s_add_u32 m0, s90, 12288
    s_add_u32 s91, s89, 98304
    buffer_load_dwordx4 v32, s[40:43], s91 offen lds
    v_lshlrev_b32 v126, 16, v107
    v_and_b32 v127, 0xffff0000, v107
    v_pk_fma_f32 v[112:113], v[120:121], v[62:63], v[112:113] op_sel:[0,0,0] op_sel_hi:[1,0,1]
    v_pk_fma_f32 v[114:115], v[122:123], v[62:63], v[114:115] op_sel:[0,0,0] op_sel_hi:[1,0,1]
    v_pk_fma_f32 v[116:117], v[124:125], v[62:63], v[116:117] op_sel:[0,0,0] op_sel_hi:[1,0,1]
    v_pk_fma_f32 v[118:119], v[126:127], v[62:63], v[118:119] op_sel:[0,0,0] op_sel_hi:[1,0,1]
    v_lshlrev_b32 v120, 16, v108
    v_and_b32 v121, 0xffff0000, v108
    v_lshlrev_b32 v122, 16, v109
    v_and_b32 v123, 0xffff0000, v109
    v_lshlrev_b32 v124, 16, v110
    v_and_b32 v125, 0xffff0000, v110
    v_lshlrev_b32 v126, 16, v111
    v_and_b32 v127, 0xffff0000, v111
    v_pk_fma_f32 v[112:113], v[120:121], v[62:63], v[112:113] op_sel:[0,1,0] op_sel_hi:[1,1,1]
    buffer_load_dwordx4 v[68:71], v1, s[32:35], s76 offen
    v_pk_fma_f32 v[114:115], v[122:123], v[62:63], v[114:115] op_sel:[0,1,0] op_sel_hi:[1,1,1]
    v_pk_fma_f32 v[116:117], v[124:125], v[62:63], v[116:117] op_sel:[0,1,0] op_sel_hi:[1,1,1]
    v_pk_fma_f32 v[118:119], v[126:127], v[62:63], v[118:119] op_sel:[0,1,0] op_sel_hi:[1,1,1]
    v_permlane32_swap_b32 v112, v113
    v_permlane32_swap_b32 v114, v115
    v_permlane32_swap_b32 v116, v117
    v_permlane32_swap_b32 v118, v119
    v_add_f32 v112, v112, v113
    v_add_f32 v114, v114, v115
    v_add_f32 v116, v116, v117
    v_add_f32 v118, v118, v119
    buffer_load_dwordx4 v[76:79], v1, s[32:35], s77 offen
    v_permlane16_swap_b32 v112, v114
    v_permlane16_swap_b32 v116, v118
    v_add_f32 v112, v112, v114
    v_add_f32 v116, v116, v118
    s_nop 0
    v_add_f32_dpp v112, v112, v112 row_ror:8 row_mask:0xf bank_mask:0xf
    v_add_f32_dpp v116, v116, v116 row_ror:8 row_mask:0xf bank_mask:0xf
    s_nop 0
    v_add_f32_dpp v112, v112, v112 row_ror:4 row_mask:0xf bank_mask:0xf
    v_add_f32_dpp v116, v116, v116 row_ror:4 row_mask:0xf bank_mask:0xf
    s_nop 0
    v_add_f32_dpp v112, v112, v112 row_ror:2 row_mask:0xf bank_mask:0xf
    v_add_f32_dpp v116, v116, v116 row_ror:2 row_mask:0xf bank_mask:0xf
    ds_write_b32 v59, v112
    ds_write_b32 v59, v116 offset:16
    s_branch Lp0j_5
Lp0e_4:
    s_add_u32 m0, s90, 8192
    s_add_u32 s91, s89, 65536
    buffer_load_dwordx4 v32, s[40:43], s91 offen lds
    s_add_u32 m0, s90, 12288
    s_add_u32 s91, s89, 98304
    buffer_load_dwordx4 v32, s[40:43], s91 offen lds
    buffer_load_dwordx4 v[68:71], v1, s[32:35], s76 offen
    buffer_load_dwordx4 v[76:79], v1, s[32:35], s77 offen
Lp0j_5:
    s_waitcnt lgkmcnt(0)
    s_barrier
    s_cmp_lg_u32 s3, 0
    s_cbranch_scc1 Lpub0_6
    s_cmp_eq_u32 s101, 3
    s_cbranch_scc1 Lpub0_7
    v_lshlrev_b32 v104, 1, v39
    v_add_u32 v105, 162816, v104
    s_lshl_b32 s69, s100, 6
    ds_read_b64 v[96:97], v105 offset:0
    ds_read_b64 v[98:99], v105 offset:64
    ds_read_b64 v[100:101], v105 offset:128
    ds_read_b64 v[102:103], v105 offset:192
    s_cmp_lg_u32 s101, 0
    s_cbranch_scc1 Lperm_8
    v_bfe_u32 v105, v0, 1, 1
    v_and_b32 v104, 1, v0
    v_lshlrev_b32 v104, 3, v104
    v_lshl_add_u32 v104, v105, 10, v104
    v_bfe_u32 v105, v0, 2, 1
    v_lshl_add_u32 v104, v105, 4, v104
    s_and_b32 s70, s100, 31
    s_lshl_b32 s70, s70, 5
    s_sub_u32 s69, s69, s70
Lperm_8:
    s_add_u32 s69, s69, 8192
    s_waitcnt lgkmcnt(0)
    v_pk_add_f32 v[96:97], v[96:97], v[98:99]
    v_pk_add_f32 v[100:101], v[100:101], v[102:103]
    v_pk_add_f32 v[96:97], v[96:97], v[100:101]
    v_cvt_pk_bf16_f32 v96, v96, v97
    v_mov_b32 v97, s66
    s_mov_b64 exec, 0xff
    buffer_store_dwordx2 v[96:97], v104, s[52:55], s69 offen sc1
    s_mov_b64 exec, -1
Lpub0_7:
    v_mov_b32 v27, s66
    v_mov_b32 v26, s26
    v_lshlrev_b32 v25, 1, v41
    s_lshl_b32 s69, s64, 6
    s_add_u32 s69, s69, 4096
    s_mov_b64 exec, 1
    buffer_store_dwordx2 v[26:27], v25, s[52:55], s69 offen sc1
    s_mov_b64 exec, -1
Lpub0_6:
    buffer_load_dwordx4 v[84:87], v1, s[32:35], s78 offen
    s_add_u32 m0, s90, 16384
    s_add_u32 s91, s89, 131072
    buffer_load_dwordx4 v32, s[40:43], s91 offen lds
    s_add_u32 m0, s90, 20480
    s_add_u32 s91, s89, 163840
    buffer_load_dwordx4 v32, s[40:43], s91 offen lds
    s_add_u32 m0, s90, 24576
    s_add_u32 s91, s89, 196608
    buffer_load_dwordx4 v32, s[40:43], s91 offen lds
    s_add_u32 m0, s90, 28672
    s_add_u32 s91, s89, 229376
    buffer_load_dwordx4 v32, s[40:43], s91 offen lds
    s_add_u32 m0, s90, 32768
    s_add_u32 s91, s89, 262144
    buffer_load_dwordx4 v32, s[40:43], s91 offen lds
    s_add_u32 m0, s90, 36864
    s_add_u32 s91, s89, 294912
    buffer_load_dwordx4 v32, s[40:43], s91 offen lds
    s_add_u32 m0, s90, 40960
    s_add_u32 s91, s89, 327680
    buffer_load_dwordx4 v32, s[40:43], s91 offen lds
    s_add_u32 m0, s90, 45056
    s_add_u32 s91, s89, 360448
    buffer_load_dwordx4 v32, s[40:43], s91 offen lds
    s_add_u32 m0, s90, 49152
    s_add_u32 s91, s89, 393216
    buffer_load_dwordx4 v32, s[40:43], s91 offen lds
    s_add_u32 m0, s90, 53248
    s_add_u32 s91, s89, 425984
    buffer_load_dwordx4 v32, s[40:43], s91 offen lds
    s_add_u32 m0, s90, 57344
    s_add_u32 s91, s89, 458752
    buffer_load_dwordx4 v32, s[40:43], s91 offen lds
    s_waitcnt vmcnt(11)
    v_dot2_f32_bf16 v88, v68, v47, 0
    v_dot2_f32_bf16 v89, v76, v47, 0
    v_dot2_f32_bf16 v90, v84, v47, 0
    v_dot2_f32_bf16 v92, v68, v68, 0
    v_dot2_f32_bf16 v93, v76, v76, 0
    v_dot2_f32_bf16 v94, v84, v84, 0
    v_dot2_f32_bf16 v88, v69, v47, v88
    v_dot2_f32_bf16 v89, v77, v47, v89
    v_dot2_f32_bf16 v90, v85, v47, v90
    v_dot2_f32_bf16 v92, v69, v69, v92
    v_dot2_f32_bf16 v93, v77, v77, v93
    v_dot2_f32_bf16 v94, v85, v85, v94
    v_dot2_f32_bf16 v88, v70, v47, v88
    v_dot2_f32_bf16 v89, v78, v47, v89
    v_dot2_f32_bf16 v90, v86, v47, v90
    s_add_u32 m0, s90, 61440
    s_add_u32 s91, s89, 491520
    buffer_load_dwordx4 v32, s[40:43], s91 offen lds
    v_dot2_f32_bf16 v92, v70, v70, v92
    v_dot2_f32_bf16 v93, v78, v78, v93
    v_dot2_f32_bf16 v94, v86, v86, v94
    v_dot2_f32_bf16 v88, v71, v47, v88
    v_dot2_f32_bf16 v89, v79, v47, v89
    v_dot2_f32_bf16 v90, v87, v47, v90
    v_dot2_f32_bf16 v92, v71, v71, v92
    v_dot2_f32_bf16 v93, v79, v79, v93
    v_dot2_f32_bf16 v94, v87, v87, v94
    v_mov_b32 v91, 0
    v_mov_b32 v95, 0
    v_lshlrev_b32 v64, 16, v68
    v_permlane32_swap_b32 v88, v90
    v_and_b32 v65, 0xffff0000, v68
    s_add_u32 m0, s88, 65536
    s_add_u32 s91, s87, 0
    buffer_load_dwordx4 v2, s[36:39], s91 offen offset:0 lds
    v_add_f32 v88, v88, v90
    v_lshlrev_b32 v66, 16, v69
    v_permlane32_swap_b32 v89, v91
    v_and_b32 v67, 0xffff0000, v69
    v_add_f32 v89, v89, v91
    v_lshlrev_b32 v68, 16, v70
    v_permlane32_swap_b32 v92, v94
    v_and_b32 v69, 0xffff0000, v70
    v_add_f32 v92, v92, v94
    v_lshlrev_b32 v70, 16, v71
    v_permlane32_swap_b32 v93, v95
    v_and_b32 v71, 0xffff0000, v71
    buffer_load_dwordx4 v2, s[36:39], s91 offen offset:1024 lds
    v_add_f32 v93, v93, v95
    v_lshlrev_b32 v72, 16, v76
    v_permlane16_swap_b32 v88, v89
    v_and_b32 v73, 0xffff0000, v76
    v_add_f32 v88, v88, v89
    v_lshlrev_b32 v74, 16, v77
    v_permlane16_swap_b32 v92, v93
    v_and_b32 v75, 0xffff0000, v77
    v_add_f32 v92, v92, v93
    v_lshlrev_b32 v76, 16, v78
    v_add_f32_dpp v88, v88, v88 row_ror:8 row_mask:0xf bank_mask:0xf
    v_and_b32 v77, 0xffff0000, v78
    v_add_f32_dpp v92, v92, v92 row_ror:8 row_mask:0xf bank_mask:0xf
    buffer_load_dwordx4 v2, s[36:39], s91 offen offset:2048 lds
    v_lshlrev_b32 v78, 16, v79
    v_add_f32_dpp v88, v88, v88 row_ror:4 row_mask:0xf bank_mask:0xf
    v_and_b32 v79, 0xffff0000, v79
    v_add_f32_dpp v92, v92, v92 row_ror:4 row_mask:0xf bank_mask:0xf
    v_lshlrev_b32 v80, 16, v84
    v_add_f32_dpp v88, v88, v88 row_ror:2 row_mask:0xf bank_mask:0xf
    v_and_b32 v81, 0xffff0000, v84
    v_add_f32_dpp v92, v92, v92 row_ror:2 row_mask:0xf bank_mask:0xf
    v_lshlrev_b32 v82, 16, v85
    v_add_f32_dpp v88, v88, v88 row_ror:1 row_mask:0xf bank_mask:0xf
    v_and_b32 v83, 0xffff0000, v85
    v_add_f32_dpp v92, v92, v92 row_ror:1 row_mask:0xf bank_mask:0xf
    v_lshlrev_b32 v84, 16, v86
    v_mul_f32 v88, 0x3b000000, v88
    v_and_b32 v85, 0xffff0000, v86
    s_add_u32 m0, s88, 81920
    s_add_u32 s91, s87, 98304
    buffer_load_dwordx4 v2, s[36:39], s91 offen offset:0 lds
    v_mul_f32 v92, 0x3b000000, v92
    v_lshlrev_b32 v86, 16, v87
    v_fma_f32 v92, -v88, v88, v92
    v_and_b32 v87, 0xffff0000, v87
    v_max_f32 v92, 0, v92
    v_add_f32 v92, 0x3727c5ac, v92
    v_rsq_f32 v92, v92
    s_nop 0
    v_mul_f32 v88, -v88, v92
    v_readlane_b32 s72, v92, 0
    v_readlane_b32 s73, v88, 0
    v_readlane_b32 s74, v92, 16
    v_readlane_b32 s75, v88, 16
    v_readlane_b32 s76, v92, 32
    v_readlane_b32 s77, v88, 32
    buffer_load_dwordx4 v2, s[36:39], s91 offen offset:1024 lds
    v_pk_fma_f32 v[64:65], v[64:65], s[72:73], s[72:73] op_sel:[0,0,1] op_sel_hi:[1,0,1]
    v_pk_fma_f32 v[66:67], v[66:67], s[72:73], s[72:73] op_sel:[0,0,1] op_sel_hi:[1,0,1]
    v_pk_fma_f32 v[68:69], v[68:69], s[72:73], s[72:73] op_sel:[0,0,1] op_sel_hi:[1,0,1]
    v_pk_fma_f32 v[70:71], v[70:71], s[72:73], s[72:73] op_sel:[0,0,1] op_sel_hi:[1,0,1]
    v_pk_fma_f32 v[72:73], v[72:73], s[74:75], s[74:75] op_sel:[0,0,1] op_sel_hi:[1,0,1]
    v_pk_fma_f32 v[74:75], v[74:75], s[74:75], s[74:75] op_sel:[0,0,1] op_sel_hi:[1,0,1]
    v_pk_fma_f32 v[76:77], v[76:77], s[74:75], s[74:75] op_sel:[0,0,1] op_sel_hi:[1,0,1]
    v_pk_fma_f32 v[78:79], v[78:79], s[74:75], s[74:75] op_sel:[0,0,1] op_sel_hi:[1,0,1]
    v_pk_fma_f32 v[80:81], v[80:81], s[76:77], s[76:77] op_sel:[0,0,1] op_sel_hi:[1,0,1]
    v_pk_fma_f32 v[82:83], v[82:83], s[76:77], s[76:77] op_sel:[0,0,1] op_sel_hi:[1,0,1]
    v_pk_fma_f32 v[84:85], v[84:85], s[76:77], s[76:77] op_sel:[0,0,1] op_sel_hi:[1,0,1]
    v_pk_fma_f32 v[86:87], v[86:87], s[76:77], s[76:77] op_sel:[0,0,1] op_sel_hi:[1,0,1]
    v_lshlrev_b32 v29, 1, v39
    s_mov_b32 s71, 8192
    v_add_u32 v27, 0x10000, v3
    v_subrev_u32 v28, 81920, v19
    buffer_load_dwordx4 v2, s[36:39], s91 offen offset:2048 lds
    s_add_u32 m0, s88, 94208
    s_add_u32 s91, s87, 196608
    buffer_load_dwordx4 v2, s[36:39], s91 offen offset:0 lds
    buffer_load_dwordx4 v2, s[36:39], s91 offen offset:1024 lds
    buffer_load_dwordx4 v2, s[36:39], s91 offen offset:2048 lds
    s_add_u32 m0, s88, 106496
    s_add_u32 s91, s87, 294912
    buffer_load_dwordx4 v2, s[36:39], s91 offen offset:0 lds
    buffer_load_dwordx4 v2, s[36:39], s91 offen offset:1024 lds
    buffer_load_dwordx4 v2, s[36:39], s91 offen offset:2048 lds
    s_waitcnt vmcnt(9)
    s_barrier
    s_add_u32 m0, s88, 118784
    s_add_u32 s91, s87, 393216
    buffer_load_dwordx4 v2, s[36:39], s91 offen offset:0 lds
    buffer_load_dwordx4 v2, s[36:39], s91 offen offset:1024 lds
    ds_read_b64_tr_b16 a[192:193], v28 offset:0
    ds_read_b64_tr_b16 a[194:195], v28 offset:512
    ds_read_b64_tr_b16 a[196:197], v28 offset:4096
    ds_read_b64_tr_b16 a[198:199], v28 offset:4608
    ds_read_b64_tr_b16 a[200:201], v28 offset:8192
    ds_read_b64_tr_b16 a[202:203], v28 offset:8704
    ds_read_b64_tr_b16 a[204:205], v28 offset:12288
    ds_read_b64_tr_b16 a[206:207], v28 offset:12800
    ds_read_b64_tr_b16 a[208:209], v28 offset:16384
    ds_read_b64_tr_b16 a[210:211], v28 offset:16896
    ds_read_b64_tr_b16 a[212:213], v28 offset:20480
    buffer_load_dwordx4 v2, s[36:39], s91 offen offset:2048 lds
    ds_read_b64_tr_b16 a[214:215], v28 offset:20992
    ds_read_b64_tr_b16 a[216:217], v28 offset:24576
    ds_read_b64_tr_b16 a[218:219], v28 offset:25088
    ds_read_b64_tr_b16 a[220:221], v28 offset:28672
    ds_read_b64_tr_b16 a[222:223], v28 offset:29184
    ds_read_b64_tr_b16 a[224:225], v28 offset:32768
    ds_read_b64_tr_b16 a[226:227], v28 offset:33280
    ds_read_b64_tr_b16 a[228:229], v28 offset:36864
    ds_read_b64_tr_b16 a[230:231], v28 offset:37376
    ds_read_b64_tr_b16 a[232:233], v28 offset:40960
    ds_read_b64_tr_b16 a[234:235], v28 offset:41472
    buffer_load_dwordx4 v[128:131], v1, s[52:55], s71 offen offset:0 sc1
    ds_read_b64_tr_b16 a[236:237], v28 offset:45056
    ds_read_b64_tr_b16 a[238:239], v28 offset:45568
    ds_read_b64_tr_b16 a[240:241], v28 offset:49152
    ds_read_b64_tr_b16 a[242:243], v28 offset:49664
    ds_read_b64_tr_b16 a[244:245], v28 offset:53248
    ds_read_b64_tr_b16 a[246:247], v28 offset:53760
    ds_read_b64_tr_b16 a[248:249], v28 offset:57344
    ds_read_b64_tr_b16 a[250:251], v28 offset:57856
    ds_read_b64_tr_b16 a[252:253], v28 offset:61440
    ds_read_b64_tr_b16 a[254:255], v28 offset:61952
    ds_read_b64_tr_b16 a[0:1], v27 offset:0
    buffer_load_dwordx4 v[132:135], v1, s[52:55], s71 offen offset:1024 sc1
    ds_read_b64_tr_b16 a[2:3], v27 offset:512
    ds_read_b64_tr_b16 a[64:65], v27 offset:1024
    ds_read_b64_tr_b16 a[66:67], v27 offset:1536
    ds_read_b64_tr_b16 a[128:129], v27 offset:2048
    ds_read_b64_tr_b16 a[130:131], v27 offset:2560
    buffer_load_dwordx4 v[136:139], v1, s[52:55], s71 offen offset:2048 sc1
    buffer_load_dwordx4 v[140:143], v1, s[52:55], s71 offen offset:3072 sc1
    buffer_load_dwordx2 v[144:145], v29, s[52:55], s24 offen sc1
    buffer_load_dword v5, v39, s[52:55], s17 offen sc1
    buffer_load_dword v5, v39, s[52:55], s17 offen offset:128 sc1
    s_add_u32 m0, s88, 131072
    s_add_u32 s91, s87, 491520
    buffer_load_dwordx4 v2, s[36:39], s91 offen offset:0 lds
    buffer_load_dwordx4 v2, s[36:39], s91 offen offset:1024 lds
    buffer_load_dwordx4 v2, s[36:39], s91 offen offset:2048 lds
    s_waitcnt vmcnt(19) lgkmcnt(0)
    s_barrier
    s_add_u32 m0, s88, 0
    s_add_u32 s91, s87, 589824
    buffer_load_dwordx4 v2, s[36:39], s91 offen offset:0 lds
    buffer_load_dwordx4 v2, s[36:39], s91 offen offset:1024 lds
    ds_read_b64_tr_b16 a[4:5], v18 offset:0
    ds_read_b64_tr_b16 a[6:7], v18 offset:512
    ds_read_b64_tr_b16 a[68:69], v18 offset:1024
    ds_read_b64_tr_b16 a[70:71], v18 offset:1536
    ds_read_b64_tr_b16 a[132:133], v18 offset:2048
    ds_read_b64_tr_b16 a[134:135], v18 offset:2560
    buffer_load_dwordx4 v2, s[36:39], s91 offen offset:2048 lds
    s_add_u32 m0, s88, 12288
    s_add_u32 s91, s87, 688128
    buffer_load_dwordx4 v2, s[36:39], s91 offen offset:0 lds
    buffer_load_dwordx4 v2, s[36:39], s91 offen offset:1024 lds
    buffer_load_dwordx4 v2, s[36:39], s91 offen offset:2048 lds
    s_add_u32 m0, s88, 24576
    s_add_u32 s91, s87, 786432
    buffer_load_dwordx4 v2, s[36:39], s91 offen offset:0 lds
    buffer_load_dwordx4 v2, s[36:39], s91 offen offset:1024 lds
    buffer_load_dwordx4 v2, s[36:39], s91 offen offset:2048 lds
    s_add_u32 m0, s88, 36864
    s_add_u32 s91, s87, 884736
    buffer_load_dwordx4 v2, s[36:39], s91 offen offset:0 lds
    buffer_load_dwordx4 v2, s[36:39], s91 offen offset:1024 lds
    buffer_load_dwordx4 v2, s[36:39], s91 offen offset:2048 lds
    s_waitcnt vmcnt(17)
    v_bitop3_b32 v25, v129, v131, s66 bitop3:0x7e
    v_bitop3_b32 v26, v133, v135, s66 bitop3:0x7e
    v_or_b32 v25, v25, v26
    v_bitop3_b32 v26, v137, v139, s66 bitop3:0x7e
    v_or_b32 v25, v25, v26
    v_bitop3_b32 v26, v141, v143, s66 bitop3:0x7e
    v_or_b32 v25, v25, v26
    v_bitop3_b32 v26, v145, v145, s66 bitop3:0x7e
    v_or_b32 v25, v25, v26
    v_cmp_ne_u32 vcc, 0, v25
    s_nop 0
    s_cbranch_vccz Lgok_10
Lg_9:
    s_sleep 16
    buffer_load_dwordx4 v[128:131], v1, s[52:55], s71 offen offset:0 sc1
    buffer_load_dwordx4 v[132:135], v1, s[52:55], s71 offen offset:1024 sc1
    buffer_load_dwordx4 v[136:139], v1, s[52:55], s71 offen offset:2048 sc1
    buffer_load_dwordx4 v[140:143], v1, s[52:55], s71 offen offset:3072 sc1
    buffer_load_dwordx2 v[144:145], v29, s[52:55], s24 offen sc1
    s_waitcnt vmcnt(0)
    v_bitop3_b32 v25, v129, v131, s66 bitop3:0x7e
    v_bitop3_b32 v26, v133, v135, s66 bitop3:0x7e
    v_or_b32 v25, v25, v26
    v_bitop3_b32 v26, v137, v139, s66 bitop3:0x7e
    v_or_b32 v25, v25, v26
    v_bitop3_b32 v26, v141, v143, s66 bitop3:0x7e
    v_or_b32 v25, v25, v26
    v_bitop3_b32 v26, v145, v145, s66 bitop3:0x7e
    v_or_b32 v25, v25, v26
    v_cmp_ne_u32 vcc, 0, v25
    s_nop 0
    s_cbranch_vccz Lgok_10
    s_add_u32 s85, s85, 1
    s_cmp_lt_u32 s85, 400000
    s_cbranch_scc1 Lg_9
Lgok_10:
    v_lshlrev_b32 v148, 16, v136
    v_and_b32 v149, 0xffff0000, v136
    v_lshlrev_b32 v150, 16, v138
    v_and_b32 v151, 0xffff0000, v138
    v_lshlrev_b32 v152, 16, v140
    v_and_b32 v153, 0xffff0000, v140
    v_lshlrev_b32 v154, 16, v142
    v_and_b32 v155, 0xffff0000, v142
    v_pk_add_f32 v[148:149], v[148:149], 1.0 op_sel_hi:[1,0]
    v_pk_add_f32 v[150:151], v[150:151], 1.0 op_sel_hi:[1,0]
    v_pk_add_f32 v[152:153], v[152:153], 1.0 op_sel_hi:[1,0]
    v_pk_add_f32 v[154:155], v[154:155], 1.0 op_sel_hi:[1,0]
    v_cvt_pk_bf16_f32 v136, v148, v149
    v_lshlrev_b32 v156, 16, v128
    v_and_b32 v157, 0xffff0000, v128
    v_cvt_pk_bf16_f32 v138, v150, v151
    v_lshlrev_b32 v158, 16, v130
    v_and_b32 v159, 0xffff0000, v130
    v_cvt_pk_bf16_f32 v140, v152, v153
    v_lshlrev_b32 v160, 16, v132
    v_and_b32 v161, 0xffff0000, v132
    v_cvt_pk_bf16_f32 v142, v154, v155
    v_lshlrev_b32 v162, 16, v134
    v_and_b32 v163, 0xffff0000, v134
    v_lshlrev_b32 v148, 16, v136
    v_and_b32 v149, 0xffff0000, v136
    v_lshlrev_b32 v150, 16, v138
    v_and_b32 v151, 0xffff0000, v138
    v_lshlrev_b32 v152, 16, v140
    v_and_b32 v153, 0xffff0000, v140
    v_lshlrev_b32 v154, 16, v142
    v_and_b32 v155, 0xffff0000, v142
    s_add_u32 s71, s86, 176128
    v_pk_fma_f32 v[64:65], v[64:65], v[148:149], v[156:157]
    v_pk_fma_f32 v[66:67], v[66:67], v[150:151], v[158:159]
    v_pk_fma_f32 v[68:69], v[68:69], v[152:153], v[160:161]
    v_pk_fma_f32 v[70:71], v[70:71], v[154:155], v[162:163]
    v_cvt_pk_bf16_f32 v64, v64, v65
    v_cvt_pk_bf16_f32 v65, v66, v67
    v_cvt_pk_bf16_f32 v66, v68, v69
    v_cvt_pk_bf16_f32 v67, v70, v71
    buffer_store_dwordx4 v[64:67], v164, s[52:55], s71 offen sc1
    v_pk_fma_f32 v[72:73], v[72:73], v[148:149], v[156:157]
    v_pk_fma_f32 v[74:75], v[74:75], v[150:151], v[158:159]
    v_pk_fma_f32 v[76:77], v[76:77], v[152:153], v[160:161]
    v_pk_fma_f32 v[78:79], v[78:79], v[154:155], v[162:163]
    v_cvt_pk_bf16_f32 v72, v72, v73
    v_cvt_pk_bf16_f32 v73, v74, v75
    v_cvt_pk_bf16_f32 v74, v76, v77
    v_cvt_pk_bf16_f32 v75, v78, v79
    buffer_store_dwordx4 v[72:75], v165, s[52:55], s71 offen sc1
    v_pk_fma_f32 v[80:81], v[80:81], v[148:149], v[156:157]
    v_pk_fma_f32 v[82:83], v[82:83], v[150:151], v[158:159]
    v_pk_fma_f32 v[84:85], v[84:85], v[152:153], v[160:161]
    v_pk_fma_f32 v[86:87], v[86:87], v[154:155], v[162:163]
    v_cvt_pk_bf16_f32 v80, v80, v81
    v_cvt_pk_bf16_f32 v81, v82, v83
    v_cvt_pk_bf16_f32 v82, v84, v85
    v_cvt_pk_bf16_f32 v83, v86, v87
    buffer_store_dwordx4 v[80:83], v166, s[52:55], s71 offen sc1
    v_cmp_ne_u32 vcc, s26, v144
    s_nop 0
    s_cmp_eq_u64 vcc, 0
    s_cselect_b32 s67, 1, 0
    buffer_load_dwordx4 v[96:99], v1, s[52:55], s23 offen offset:0 sc1
    buffer_load_dwordx4 v[100:103], v1, s[52:55], s23 offen offset:1024 sc1
    s_add_u32 m0, s88, 49152
    s_add_u32 s91, s87, 983040
    buffer_load_dwordx4 v2, s[36:39], s91 offen offset:0 lds
    buffer_load_dwordx4 v2, s[36:39], s91 offen offset:1024 lds
    buffer_load_dwordx4 v2, s[36:39], s91 offen offset:2048 lds
    s_add_u32 m0, s88, 61440
    s_add_u32 s91, s87, 1081344
    buffer_load_dwordx4 v2, s[36:39], s91 offen offset:0 lds
    buffer_load_dwordx4 v2, s[36:39], s91 offen offset:1024 lds
    buffer_load_dwordx4 v2, s[36:39], s91 offen offset:2048 lds
    s_waitcnt vmcnt(23) lgkmcnt(0)
    s_barrier
    s_add_u32 m0, s88, 81920
    s_add_u32 s91, s87, 1179648
    buffer_load_dwordx4 v2, s[36:39], s91 offen offset:0 lds
    buffer_load_dwordx4 v2, s[36:39], s91 offen offset:1024 lds
    ds_read_b64_tr_b16 a[8:9], v18 offset:12288
    ds_read_b64_tr_b16 a[10:11], v18 offset:12800
    ds_read_b64_tr_b16 a[72:73], v18 offset:13312
    ds_read_b64_tr_b16 a[74:75], v18 offset:13824
    ds_read_b64_tr_b16 a[136:137], v18 offset:14336
    ds_read_b64_tr_b16 a[138:139], v18 offset:14848
    ds_read_b64_tr_b16 a[12:13], v18 offset:24576
    ds_read_b64_tr_b16 a[14:15], v18 offset:25088
    ds_read_b64_tr_b16 a[76:77], v18 offset:25600
    ds_read_b64_tr_b16 a[78:79], v18 offset:26112
    ds_read_b64_tr_b16 a[140:141], v18 offset:26624
    buffer_load_dwordx4 v2, s[36:39], s91 offen offset:2048 lds
    ds_read_b64_tr_b16 a[142:143], v18 offset:27136
    ds_read_b64_tr_b16 a[16:17], v18 offset:36864
    ds_read_b64_tr_b16 a[18:19], v18 offset:37376
    ds_read_b64_tr_b16 a[80:81], v18 offset:37888
    ds_read_b64_tr_b16 a[82:83], v18 offset:38400
    ds_read_b64_tr_b16 a[144:145], v18 offset:38912
    ds_read_b64_tr_b16 a[146:147], v18 offset:39424
    ds_read_b64_tr_b16 a[20:21], v18 offset:49152
    ds_read_b64_tr_b16 a[22:23], v18 offset:49664
    ds_read_b64_tr_b16 a[84:85], v18 offset:50176
    ds_read_b64_tr_b16 a[86:87], v18 offset:50688
    ds_read_b64_tr_b16 a[148:149], v18 offset:51200
    ds_read_b64_tr_b16 a[150:151], v18 offset:51712
    s_waitcnt vmcnt(20) lgkmcnt(0)
    s_and_b32 s69, s92, 31
    s_mul_i32 s69, s69, 1024
    v_min_u32 v61, 896, v4
    v_add_u32 v61, s69, v61
    v_and_b32 v25, 1, v24
    v_and_b32 v62, 0x1ff, v37
    v_lshl_add_u32 v63, v25, 30, v62
    v_lshl_add_u32 v62, v25, 9, v62
    s_add_u32 s72, s71, s25
    s_waitcnt vmcnt(11)
    s_barrier
    s_cmp_lg_u32 s3, 0
    s_cbranch_scc1 Lpub_11
    s_add_u32 s20, s66, 1
    v_mov_b32 v60, s20
    s_mov_b64 exec, 1
    s_cmp_eq_u32 s67, 1
    s_cbranch_scc1 Lpub_12
    buffer_store_dword v60, v41, s[52:55], s17 offen offset:0 sc1
    s_mov_b64 exec, -1
    s_branch Lpub_11
Lpub_12:
    buffer_store_dword v60, v41, s[52:55], s17 offen offset:0
    s_mov_b64 exec, -1
Lpub_11:
    global_load_dword v5, v61, s[0:1]
    s_add_u32 m0, s88, 94208
    s_add_u32 s91, s87, 1277952
    buffer_load_dwordx4 v2, s[36:39], s91 offen offset:0 lds
    ds_read_b64_tr_b16 a[24:25], v3 offset:0
    ds_read_b64_tr_b16 a[26:27], v3 offset:512
    ds_read_b64_tr_b16 a[88:89], v3 offset:1024
    ds_read_b64_tr_b16 a[90:91], v3 offset:1536
    ds_read_b64_tr_b16 a[152:153], v3 offset:2048
    ds_read_b64_tr_b16 a[154:155], v3 offset:2560
    ds_read_b64_tr_b16 a[28:29], v3 offset:12288
    ds_read_b64_tr_b16 a[30:31], v3 offset:12800
    ds_read_b64_tr_b16 a[92:93], v3 offset:13312
    ds_read_b64_tr_b16 a[94:95], v3 offset:13824
    ds_read_b64_tr_b16 a[156:157], v3 offset:14336
    buffer_load_dwordx4 v2, s[36:39], s91 offen offset:1024 lds
    ds_read_b64_tr_b16 a[158:159], v3 offset:14848
    s_waitcnt vmcnt(12)
    v_bitop3_b32 v25, v97, v99, s66 bitop3:0x7e
    v_bitop3_b32 v26, v101, v103, s66 bitop3:0x7e
    v_or_b32 v25, v25, v26
    v_cmp_ne_u32 vcc, 0, v25
    s_nop 0
    s_cbranch_vccz Lgok_14
Lg_13:
    s_sleep 16
    buffer_load_dwordx4 v[96:99], v1, s[52:55], s23 offen offset:0 sc1
    buffer_load_dwordx4 v[100:103], v1, s[52:55], s23 offen offset:1024 sc1
    s_waitcnt vmcnt(0)
    v_bitop3_b32 v25, v97, v99, s66 bitop3:0x7e
    v_bitop3_b32 v26, v101, v103, s66 bitop3:0x7e
    v_or_b32 v25, v25, v26
    v_cmp_ne_u32 vcc, 0, v25
    s_nop 0
    s_cbranch_vccz Lgok_14
    s_add_u32 s85, s85, 1
    s_cmp_lt_u32 s85, 400000
    s_cbranch_scc1 Lg_13
Lgok_14:
    s_cmp_eq_u32 s3, 2
    s_cselect_b32 s70, 1.0, 0
    v_lshlrev_b32 v27, 16, v96
    v_and_b32 v28, 0xffff0000, v96
    v_add_f32 v27, s70, v27
    v_add_f32 v28, s70, v28
    v_cvt_pk_bf16_f32 v104, v27, v28
    v_lshlrev_b32 v27, 16, v98
    v_and_b32 v28, 0xffff0000, v98
    v_add_f32 v27, s70, v27
    v_add_f32 v28, s70, v28
    v_cvt_pk_bf16_f32 v105, v27, v28
    v_lshlrev_b32 v27, 16, v100
    v_and_b32 v28, 0xffff0000, v100
    v_add_f32 v27, s70, v27
    v_add_f32 v28, s70, v28
    v_cvt_pk_bf16_f32 v106, v27, v28
    v_lshlrev_b32 v27, 16, v102
    v_and_b32 v28, 0xffff0000, v102
    v_add_f32 v27, s70, v27
    v_add_f32 v28, s70, v28
    v_cvt_pk_bf16_f32 v107, v27, v28
    s_add_u32 s69, s90, 147456
    v_add_u32 v29, s69, v43
    ds_write_b64 v29, v[104:105] offset:0
    ds_write_b64 v29, v[106:107] offset:512
    s_waitcnt lgkmcnt(0)
    buffer_load_dwordx4 v2, s[36:39], s91 offen offset:2048 lds
    s_add_u32 m0, s88, 106496
    s_add_u32 s91, s87, 1376256
    buffer_load_dwordx4 v2, s[36:39], s91 offen offset:0 lds
    buffer_load_dwordx4 v2, s[36:39], s91 offen offset:1024 lds
    buffer_load_dwordx4 v2, s[36:39], s91 offen offset:2048 lds
    buffer_load_dword v40, v39, s[52:55], s17 offen offset:0 sc1
    s_waitcnt vmcnt(11)
    s_barrier
    s_add_u32 m0, s88, 118784
    s_add_u32 s91, s87, 1474560
    buffer_load_dwordx4 v2, s[36:39], s91 offen offset:0 lds
    buffer_load_dwordx4 v2, s[36:39], s91 offen offset:1024 lds
    ds_read_b64_tr_b16 a[32:33], v3 offset:24576
    ds_read_b64_tr_b16 a[34:35], v3 offset:25088
    ds_read_b64_tr_b16 a[96:97], v3 offset:25600
    ds_read_b64_tr_b16 a[98:99], v3 offset:26112
    ds_read_b64_tr_b16 a[160:161], v3 offset:26624
    ds_read_b64_tr_b16 a[162:163], v3 offset:27136
    ds_read_b64_tr_b16 a[36:37], v3 offset:36864
    ds_read_b64_tr_b16 a[38:39], v3 offset:37376
    ds_read_b64_tr_b16 a[100:101], v3 offset:37888
    ds_read_b64_tr_b16 a[102:103], v3 offset:38400
    ds_read_b64_tr_b16 a[164:165], v3 offset:38912
    buffer_load_dwordx4 v2, s[36:39], s91 offen offset:2048 lds
    ds_read_b64_tr_b16 a[166:167], v3 offset:39424
    ds_read_b64_tr_b16 a[40:41], v3 offset:49152
    ds_read_b64_tr_b16 a[42:43], v3 offset:49664
    ds_read_b64_tr_b16 a[104:105], v3 offset:50176
    ds_read_b64_tr_b16 a[106:107], v3 offset:50688
    ds_read_b64_tr_b16 a[168:169], v3 offset:51200
    ds_read_b64_tr_b16 a[170:171], v3 offset:51712
    ds_read_b64_tr_b16 a[44:45], v3 offset:61440
    ds_read_b64_tr_b16 a[46:47], v3 offset:61952
    ds_read_b64_tr_b16 a[108:109], v3 offset:62464
    ds_read_b64_tr_b16 a[110:111], v3 offset:62976
    ds_read_b64_tr_b16 a[172:173], v3 offset:63488
    ds_read_b64_tr_b16 a[174:175], v3 offset:64000
    v_and_b32 v30, 0xfffffff7, v42
    v_add_u32 v26, 145408, v1
    ds_read_b128 v[144:147], v26 offset:4096
    ds_read_b128 v[148:151], v26 offset:3072
    ds_read_b64 v[226:227], v42 offset:2048
    ds_read_b64 v[230:231], v42 offset:4096
    ds_read_b128 v[232:235], v30 offset:4096
    ds_read_b128 v[236:239], v30 offset:3072
    s_waitcnt lgkmcnt(0)
    v_dot2_f32_bf16 v244, v144, v47, 0
    v_dot2_f32_bf16 v245, v144, v144, 0
    v_dot2_f32_bf16 v246, v148, v47, 0
    v_dot2_f32_bf16 v247, v148, v148, 0
    v_dot2_f32_bf16 v248, v144, v148, 0
    v_dot2_f32_bf16 v244, v145, v47, v244
    v_dot2_f32_bf16 v245, v145, v145, v245
    v_dot2_f32_bf16 v246, v149, v47, v246
    v_dot2_f32_bf16 v247, v149, v149, v247
    v_dot2_f32_bf16 v248, v145, v149, v248
    v_dot2_f32_bf16 v244, v146, v47, v244
    v_dot2_f32_bf16 v245, v146, v146, v245
    v_dot2_f32_bf16 v246, v150, v47, v246
    v_dot2_f32_bf16 v247, v150, v150, v247
    v_dot2_f32_bf16 v248, v146, v150, v248
    v_dot2_f32_bf16 v244, v147, v47, v244
    v_dot2_f32_bf16 v245, v147, v147, v245
    v_dot2_f32_bf16 v246, v151, v47, v246
    v_dot2_f32_bf16 v247, v151, v151, v247
    v_dot2_f32_bf16 v248, v147, v151, v248
    s_add_u32 s20, s66, 1
    s_waitcnt vmcnt(3)
    v_cmp_ne_u32 s[28:29], s20, v40
    s_nop 0
    s_cmp_eq_u64 s[28:29], 0
    s_cbranch_scc1 Lwok_16
Lw_15:
    buffer_load_dword v40, v39, s[52:55], s17 offen offset:0 sc1
    s_waitcnt vmcnt(0)
    v_cmp_ne_u32 s[28:29], s20, v40
    s_nop 0
    s_cmp_eq_u64 s[28:29], 0
    s_cbranch_scc1 Lwok_16
    s_add_u32 s85, s85, 1
    s_cmp_lt_u32 s85, 400000
    s_cbranch_scc1 Lw_15
Lwok_16:
    s_barrier
    s_add_u32 m0, s25, 0
    s_add_u32 s91, s72, 0
    buffer_load_dwordx4 v1, s[52:55], s91 offen offset:0 sc1 lds
    buffer_load_dwordx4 v1, s[52:55], s91 offen offset:1024 sc1 lds
    buffer_load_dwordx4 v1, s[52:55], s91 offen offset:2048 sc1 lds
    buffer_load_dwordx4 v1, s[52:55], s91 offen offset:3072 sc1 lds
    s_add_u32 m0, s25, 16384
    s_add_u32 s91, s72, 16384
    buffer_load_dwordx4 v1, s[52:55], s91 offen offset:0 sc1 lds
    buffer_load_dwordx4 v1, s[52:55], s91 offen offset:1024 sc1 lds
    buffer_load_dwordx4 v1, s[52:55], s91 offen offset:2048 sc1 lds
    buffer_load_dwordx4 v1, s[52:55], s91 offen offset:3072 sc1 lds
    s_add_u32 m0, s25, 32768
    s_add_u32 s91, s72, 32768
    buffer_load_dwordx4 v1, s[52:55], s91 offen offset:0 sc1 lds
    buffer_load_dwordx4 v1, s[52:55], s91 offen offset:1024 sc1 lds
    buffer_load_dwordx4 v1, s[52:55], s91 offen offset:2048 sc1 lds
    buffer_load_dwordx4 v1, s[52:55], s91 offen offset:3072 sc1 lds
    s_add_u32 m0, s25, 49152
    s_add_u32 s91, s72, 49152
    buffer_load_dwordx4 v1, s[52:55], s91 offen offset:0 sc1 lds
    buffer_load_dwordx4 v1, s[52:55], s91 offen offset:1024 sc1 lds
    ds_read_b64_tr_b16 a[48:49], v18 offset:0
    ds_read_b64_tr_b16 a[50:51], v18 offset:512
    ds_read_b64_tr_b16 a[112:113], v18 offset:1024
    ds_read_b64_tr_b16 a[114:115], v18 offset:1536
    ds_read_b64_tr_b16 a[176:177], v18 offset:2048
    ds_read_b64_tr_b16 a[178:179], v18 offset:2560
    ds_read_b64_tr_b16 a[52:53], v18 offset:12288
    ds_read_b64_tr_b16 a[54:55], v18 offset:12800
    ds_read_b64_tr_b16 a[116:117], v18 offset:13312
    ds_read_b64_tr_b16 a[118:119], v18 offset:13824
    ds_read_b64_tr_b16 a[180:181], v18 offset:14336
    ds_read_b64_tr_b16 a[182:183], v18 offset:14848
    s_mov_b32 s73, 0x3eb8aa3b
    s_add_u32 s74, s16, 32768
    s_waitcnt vmcnt(10)
    s_barrier
    ds_read_b128 v[64:67], v14 offset:0
    ds_read_b128 v[68:71], v15 offset:0
    ds_read_b128 v[72:75], v16 offset:0
    ds_read_b128 v[76:79], v17 offset:0
    ds_read_b128 v[80:83], v14 offset:256
    ds_read_b128 v[84:87], v15 offset:256
    ds_read_b128 v[88:91], v16 offset:256
    s_waitcnt lgkmcnt(5)
    v_mfma_f32_16x16x32_bf16 v[96:99], a[64:67], v[64:67], 0
    ds_read_b128 v[92:95], v17 offset:256
    v_lshlrev_b32 v224, 16, v226
    v_mfma_f32_16x16x32_bf16 v[100:103], v[64:67], a[128:131], 0
    buffer_load_dwordx4 v1, s[52:55], s91 offen offset:2048 sc1 lds
    v_and_b32 v225, 0xffff0000, v226
    v_mfma_f32_16x16x32_bf16 v[96:99], a[68:71], v[68:71], v[96:99]
    ds_read_b128 v[64:67], v14 offset:512
    v_lshlrev_b32 v226, 16, v227
    v_mfma_f32_16x16x32_bf16 v[100:103], v[68:71], a[132:135], v[100:103]
    buffer_load_dwordx4 v1, s[52:55], s91 offen offset:3072 sc1 lds
    s_waitcnt lgkmcnt(5)
    v_mfma_f32_16x16x32_bf16 v[96:99], a[72:75], v[72:75], v[96:99]
    ds_read_b128 v[68:71], v15 offset:512
    v_and_b32 v227, 0xffff0000, v227
    v_mfma_f32_16x16x32_bf16 v[100:103], v[72:75], a[136:139], v[100:103]
    ds_read_b64_tr_b16 a[56:57], v18 offset:24576
    v_lshlrev_b32 v228, 16, v230
    v_mfma_f32_16x16x32_bf16 v[96:99], a[76:79], v[76:79], v[96:99]
    ds_read_b128 v[72:75], v16 offset:512
    v_and_b32 v229, 0xffff0000, v230
    v_mfma_f32_16x16x32_bf16 v[100:103], v[76:79], a[140:143], v[100:103]
    buffer_load_dword v5, v251, s[44:47], 0 offen
    s_waitcnt lgkmcnt(6)
    v_mfma_f32_16x16x32_bf16 v[96:99], a[80:83], v[80:83], v[96:99]
    ds_read_b128 v[76:79], v17 offset:512
    v_lshlrev_b32 v230, 16, v231
    v_mfma_f32_16x16x32_bf16 v[100:103], v[80:83], a[144:147], v[100:103]
    ds_read_b64_tr_b16 a[58:59], v18 offset:25088
    v_and_b32 v231, 0xffff0000, v231
    v_mfma_f32_16x16x32_bf16 v[96:99], a[84:87], v[84:87], v[96:99]
    ds_read_b128 v[80:83], v14 offset:768
    v_mfma_f32_16x16x32_bf16 v[100:103], v[84:87], a[148:151], v[100:103]
    global_load_ushort v55, v252, s[14:15] offset:0
    s_waitcnt lgkmcnt(7)
    v_mfma_f32_16x16x32_bf16 v[96:99], a[88:91], v[88:91], v[96:99]
    ds_read_b128 v[84:87], v15 offset:768
    v_mfma_f32_16x16x32_bf16 v[100:103], v[88:91], a[152:155], v[100:103]
    global_load_ushort v56, v252, s[14:15] offset:32
    v_mfma_f32_16x16x32_bf16 v[96:99], a[92:95], v[92:95], v[96:99]
    ds_read_b128 v[88:91], v16 offset:768
    v_mfma_f32_16x16x32_bf16 v[100:103], v[92:95], a[156:159], v[100:103]
    ds_read_b64_tr_b16 a[120:121], v18 offset:25600
    ds_read_b64_tr_b16 a[122:123], v18 offset:26112
    ds_read_b64_tr_b16 a[184:185], v18 offset:26624
    ds_read_b64_tr_b16 a[186:187], v18 offset:27136
    ds_read_b64_tr_b16 a[60:61], v18 offset:36864
    ds_read_b64_tr_b16 a[62:63], v18 offset:37376
    ds_read_b64_tr_b16 a[124:125], v18 offset:37888
    ds_read_b64_tr_b16 a[126:127], v18 offset:38400
    ds_read_b64_tr_b16 a[188:189], v18 offset:38912
    ds_read_b64_tr_b16 a[190:191], v18 offset:39424
    s_waitcnt vmcnt(11) lgkmcnt(0)
    s_barrier
    v_mfma_f32_16x16x32_bf16 v[96:99], a[96:99], v[64:67], v[96:99]
    ds_read_b128 v[92:95], v17 offset:768
    v_mfma_f32_16x16x32_bf16 v[100:103], v[64:67], a[160:163], v[100:103]
    global_load_ushort v57, v252, s[14:15] offset:64
    s_mov_b32 m0, 163072
    v_mfma_f32_16x16x32_bf16 v[96:99], a[100:103], v[68:71], v[96:99]
    ds_read_b128 v[64:67], v14 offset:16384
    v_mfma_f32_16x16x32_bf16 v[100:103], v[68:71], a[164:167], v[100:103]
    global_load_lds_dword v253, s[18:19]
    v_mfma_f32_16x16x32_bf16 v[96:99], a[104:107], v[72:75], v[96:99]
    ds_read_b128 v[68:71], v15 offset:16384
    v_mfma_f32_16x16x32_bf16 v[100:103], v[72:75], a[168:171], v[100:103]
    buffer_load_dword v5, v41, s[56:59], s96 offen
    s_lshl_b32 m0, s90, 1
    v_mfma_f32_16x16x32_bf16 v[96:99], a[108:111], v[76:79], v[96:99]
    ds_read_b128 v[72:75], v16 offset:16384
    s_add_u32 m0, m0, 152576
    v_mfma_f32_16x16x32_bf16 v[100:103], v[76:79], a[172:175], v[100:103]
    buffer_load_dwordx4 v250, s[32:35], s93 offen lds
    v_mfma_f32_16x16x32_bf16 v[96:99], a[112:115], v[80:83], v[96:99]
    ds_read_b128 v[76:79], v17 offset:16384
    s_lshl_b32 m0, s90, 1
    v_mfma_f32_16x16x32_bf16 v[100:103], v[80:83], a[176:179], v[100:103]
    s_add_u32 m0, m0, 153600
    v_mfma_f32_16x16x32_bf16 v[96:99], a[116:119], v[84:87], v[96:99]
    ds_read_b128 v[80:83], v14 offset:16640
    v_mfma_f32_16x16x32_bf16 v[100:103], v[84:87], a[180:183], v[100:103]
    buffer_load_dwordx4 v254, s[32:35], s93 offen lds
    s_waitcnt lgkmcnt(5)
    v_mfma_f32_16x16x32_bf16 v[96:99], a[120:123], v[88:91], v[96:99]
    ds_read_b128 v[84:87], v15 offset:16640
    v_mfma_f32_16x16x32_bf16 v[100:103], v[88:91], a[184:187], v[100:103]
    buffer_load_dword v5, v178, s[48:51], 0 offen
    s_add_u32 m0, s25, 65536
    v_mfma_f32_16x16x32_bf16 v[96:99], a[124:127], v[92:95], v[96:99]
    ds_read_b128 v[88:91], v16 offset:16640
    s_add_u32 s91, s72, 65536
    v_mfma_f32_16x16x32_bf16 v[100:103], v[92:95], a[188:191], v[100:103]
    buffer_load_dwordx4 v1, s[52:55], s91 offen offset:0 sc1 lds
    s_waitcnt lgkmcnt(5)
    v_mfma_f32_16x16x32_bf16 v[108:111], a[64:67], v[64:67], 0
    ds_read_b128 v[92:95], v17 offset:16640
    v_mfma_f32_16x16x32_bf16 v[112:115], v[64:67], a[128:131], 0
    buffer_load_dwordx4 v1, s[52:55], s91 offen offset:1024 sc1 lds
    v_mfma_f32_16x16x32_bf16 v[116:119], a[0:3], v[64:67], 0
    v_permlane32_swap_b32 v244, v246
    v_mfma_f32_16x16x32_bf16 v[108:111], a[68:71], v[68:71], v[108:111]
    ds_read_b128 v[64:67], v14 offset:16896
    v_add_f32 v244, v244, v246
    v_mfma_f32_16x16x32_bf16 v[112:115], v[68:71], a[132:135], v[112:115]
    v_permlane32_swap_b32 v245, v247
    v_mfma_f32_16x16x32_bf16 v[116:119], a[4:7], v[68:71], v[116:119]
    v_add_f32 v245, v245, v247
    s_waitcnt lgkmcnt(5)
    v_mfma_f32_16x16x32_bf16 v[108:111], a[72:75], v[72:75], v[108:111]
    ds_read_b128 v[68:71], v15 offset:16896
    v_mov_b32 v249, v248
    v_mfma_f32_16x16x32_bf16 v[112:115], v[72:75], a[136:139], v[112:115]
    v_mfma_f32_16x16x32_bf16 v[116:119], a[8:11], v[72:75], v[116:119]
    v_permlane16_swap_b32 v244, v245
    v_mfma_f32_16x16x32_bf16 v[108:111], a[76:79], v[76:79], v[108:111]
    ds_read_b128 v[72:75], v16 offset:16896
    v_add_f32 v244, v244, v245
    v_mfma_f32_16x16x32_bf16 v[112:115], v[76:79], a[140:143], v[112:115]
    v_permlane32_swap_b32 v248, v249
    v_mfma_f32_16x16x32_bf16 v[116:119], a[12:15], v[76:79], v[116:119]
    v_add_f32 v248, v248, v249
    s_waitcnt lgkmcnt(5)
    v_mfma_f32_16x16x32_bf16 v[108:111], a[80:83], v[80:83], v[108:111]
    ds_read_b128 v[76:79], v17 offset:16896
    v_mov_b32 v249, v248
    v_mfma_f32_16x16x32_bf16 v[112:115], v[80:83], a[144:147], v[112:115]
    v_mfma_f32_16x16x32_bf16 v[116:119], a[16:19], v[80:83], v[116:119]
    v_permlane16_swap_b32 v248, v249
    v_mfma_f32_16x16x32_bf16 v[108:111], a[84:87], v[84:87], v[108:111]
    ds_read_b128 v[80:83], v14 offset:17152
    v_add_f32 v248, v248, v249
    v_mfma_f32_16x16x32_bf16 v[112:115], v[84:87], a[148:151], v[112:115]
    v_mfma_f32_16x16x32_bf16 v[116:119], a[20:23], v[84:87], v[116:119]
    v_add_f32_dpp v244, v244, v244 row_ror:8 row_mask:0xf bank_mask:0xf
    s_waitcnt lgkmcnt(5)
    v_mfma_f32_16x16x32_bf16 v[108:111], a[88:91], v[88:91], v[108:111]
    ds_read_b128 v[84:87], v15 offset:17152
    v_add_f32_dpp v248, v248, v248 row_ror:8 row_mask:0xf bank_mask:0xf
    v_mfma_f32_16x16x32_bf16 v[112:115], v[88:91], a[152:155], v[112:115]
    v_mfma_f32_16x16x32_bf16 v[116:119], a[24:27], v[88:91], v[116:119]
    v_add_f32_dpp v244, v244, v244 row_ror:4 row_mask:0xf bank_mask:0xf
    v_add_f32_dpp v248, v248, v248 row_ror:4 row_mask:0xf bank_mask:0xf
    v_mfma_f32_16x16x32_bf16 v[108:111], a[92:95], v[92:95], v[108:111]
    ds_read_b128 v[88:91], v16 offset:17152
    v_mfma_f32_16x16x32_bf16 v[112:115], v[92:95], a[156:159], v[112:115]
    v_add_f32_dpp v244, v244, v244 row_ror:2 row_mask:0xf bank_mask:0xf
    v_add_f32_dpp v248, v248, v248 row_ror:2 row_mask:0xf bank_mask:0xf
    v_mfma_f32_16x16x32_bf16 v[116:119], a[28:31], v[92:95], v[116:119]
    s_waitcnt vmcnt(15)
    s_barrier
    s_waitcnt lgkmcnt(5)
    v_mfma_f32_16x16x32_bf16 v[108:111], a[96:99], v[64:67], v[108:111]
    ds_read_b128 v[92:95], v17 offset:17152
    v_add_f32_dpp v244, v244, v244 row_ror:1 row_mask:0xf bank_mask:0xf
    v_mfma_f32_16x16x32_bf16 v[112:115], v[64:67], a[160:163], v[112:115]
    v_add_f32_dpp v248, v248, v248 row_ror:1 row_mask:0xf bank_mask:0xf
    v_mul_f32 v244, 0x3b000000, v244
    v_mfma_f32_16x16x32_bf16 v[116:119], a[32:35], v[64:67], v[116:119]
    v_mul_f32 v248, 0x3b000000, v248
    v_readlane_b32 s80, v244, 0
    v_mfma_f32_16x16x32_bf16 v[108:111], a[100:103], v[68:71], v[108:111]
    ds_read_b128 v[64:67], v14 offset:32768
    v_readlane_b32 s81, v244, 16
    v_mfma_f32_16x16x32_bf16 v[112:115], v[68:71], a[164:167], v[112:115]
    v_readlane_b32 s82, v244, 32
    v_readlane_b32 s83, v244, 48
    v_mfma_f32_16x16x32_bf16 v[116:119], a[36:39], v[68:71], v[116:119]
    v_readlane_b32 s84, v248, 0
    s_waitcnt lgkmcnt(5)
    v_mfma_f32_16x16x32_bf16 v[108:111], a[104:107], v[72:75], v[108:111]
    ds_read_b128 v[68:71], v15 offset:32768
    v_mfma_f32_16x16x32_bf16 v[112:115], v[72:75], a[168:171], v[112:115]
    v_mfma_f32_16x16x32_bf16 v[116:119], a[40:43], v[72:75], v[116:119]
    v_mfma_f32_16x16x32_bf16 v[108:111], a[108:111], v[76:79], v[108:111]
    ds_read_b128 v[72:75], v16 offset:32768
    v_cvt_pk_bf16_f32 v156, v96, v97
    v_mfma_f32_16x16x32_bf16 v[112:115], v[76:79], a[172:175], v[112:115]
    v_cvt_pk_bf16_f32 v157, v98, v99
    v_cvt_pk_bf16_f32 v166, v100, v101
    v_mfma_f32_16x16x32_bf16 v[116:119], a[44:47], v[76:79], v[116:119]
    v_cvt_pk_bf16_f32 v167, v102, v103
    s_waitcnt lgkmcnt(5)
    v_mfma_f32_16x16x32_bf16 v[108:111], a[112:115], v[80:83], v[108:111]
    ds_read_b128 v[76:79], v17 offset:32768
    v_mfma_f32_16x16x32_bf16 v[112:115], v[80:83], a[176:179], v[112:115]
    v_mfma_f32_16x16x32_bf16 v[116:119], a[48:51], v[80:83], v[116:119]
    v_mfma_f32_16x16x32_bf16 v[108:111], a[116:119], v[84:87], v[108:111]
    ds_read_b128 v[80:83], v14 offset:33024
    v_mfma_f32_16x16x32_bf16 v[112:115], v[84:87], a[180:183], v[112:115]
    v_mfma_f32_16x16x32_bf16 v[116:119], a[52:55], v[84:87], v[116:119]
    s_waitcnt lgkmcnt(5)
    v_mfma_f32_16x16x32_bf16 v[108:111], a[120:123], v[88:91], v[108:111]
    ds_read_b128 v[84:87], v15 offset:33024
    v_mfma_f32_16x16x32_bf16 v[112:115], v[88:91], a[184:187], v[112:115]
    v_mfma_f32_16x16x32_bf16 v[116:119], a[56:59], v[88:91], v[116:119]
    v_mfma_f32_16x16x32_bf16 v[108:111], a[124:127], v[92:95], v[108:111]
    ds_read_b128 v[88:91], v16 offset:33024
    v_mfma_f32_16x16x32_bf16 v[112:115], v[92:95], a[188:191], v[112:115]
    v_mfma_f32_16x16x32_bf16 v[116:119], a[60:63], v[92:95], v[116:119]
    s_waitcnt lgkmcnt(5)
    v_mfma_f32_16x16x32_bf16 v[120:123], a[64:67], v[64:67], 0
    ds_read_b128 v[92:95], v17 offset:33024
    v_mfma_f32_16x16x32_bf16 v[124:127], v[64:67], a[128:131], 0
    v_mfma_f32_16x16x32_bf16 v[128:131], a[0:3], v[64:67], 0
    v_mfma_f32_16x16x32_bf16 v[120:123], a[68:71], v[68:71], v[120:123]
    ds_read_b128 v[64:67], v14 offset:33280
    v_cvt_pk_bf16_f32 v158, v108, v109
    v_cvt_pk_bf16_f32 v159, v110, v111
    v_mfma_f32_16x16x32_bf16 v[124:127], v[68:71], a[132:135], v[124:127]
    v_cvt_pk_bf16_f32 v176, v116, v117
    v_cvt_pk_bf16_f32 v177, v118, v119
    v_mfma_f32_16x16x32_bf16 v[128:131], a[4:7], v[68:71], v[128:131]
    v_cvt_pk_bf16_f32 v168, v112, v113
    s_waitcnt lgkmcnt(5)
    v_mfma_f32_16x16x32_bf16 v[120:123], a[72:75], v[72:75], v[120:123]
    ds_read_b128 v[68:71], v15 offset:33280
    v_cvt_pk_bf16_f32 v169, v114, v115
    v_mfma_f32_16x16x16_bf16 v[200:203], v[156:157], v[176:177], 0
    v_mfma_f32_16x16x16_bf16 v[204:207], v[158:159], v[176:177], 0
    buffer_load_dwordx4 v1, s[52:55], s91 offen offset:2048 sc1 lds
    v_mfma_f32_16x16x32_bf16 v[124:127], v[72:75], a[136:139], v[124:127]
    v_mfma_f32_16x16x32_bf16 v[128:131], a[8:11], v[72:75], v[128:131]
    v_mfma_f32_16x16x32_bf16 v[120:123], a[76:79], v[76:79], v[120:123]
    ds_read_b128 v[72:75], v16 offset:33280
    v_mfma_f32_16x16x32_bf16 v[124:127], v[76:79], a[140:143], v[124:127]
    buffer_load_dwordx4 v1, s[52:55], s91 offen offset:3072 sc1 lds
    s_add_u32 m0, s88, 81920
    v_mfma_f32_16x16x32_bf16 v[128:131], a[12:15], v[76:79], v[128:131]
    s_add_u32 s91, s22, 0
    s_waitcnt lgkmcnt(5)
    v_mfma_f32_16x16x32_bf16 v[120:123], a[80:83], v[80:83], v[120:123]
    ds_read_b128 v[76:79], v17 offset:33280
    v_min_f32 v200, s99, v200
    v_min_f32 v201, s99, v201
    v_mfma_f32_16x16x32_bf16 v[124:127], v[80:83], a[144:147], v[124:127]
    v_min_f32 v202, s99, v202
    v_min_f32 v203, s99, v203
    v_mfma_f32_16x16x32_bf16 v[128:131], a[16:19], v[80:83], v[128:131]
    v_cndmask_b32 v200, v200, v204, s[4:5]
    v_cndmask_b32 v201, v201, v205, s[6:7]
    v_mfma_f32_16x16x32_bf16 v[120:123], a[84:87], v[84:87], v[120:123]
    ds_read_b128 v[80:83], v14 offset:33536
    v_cndmask_b32 v202, v202, v206, s[8:9]
    v_cndmask_b32 v203, v203, v207, s[10:11]
    v_mfma_f32_16x16x32_bf16 v[124:127], v[84:87], a[148:151], v[124:127]
    v_cndmask_b32 v200, v200, v201, s[12:13]
    v_cndmask_b32 v201, v202, v203, s[12:13]
    v_mfma_f32_16x16x32_bf16 v[128:131], a[20:23], v[84:87], v[128:131]
    v_max_f32 v202, v200, v201
    s_waitcnt lgkmcnt(5)
    v_mfma_f32_16x16x32_bf16 v[120:123], a[88:91], v[88:91], v[120:123]
    ds_read_b128 v[84:87], v15 offset:33536
    v_mov_b32 v203, v202
    v_mfma_f32_16x16x32_bf16 v[124:127], v[88:91], a[152:155], v[124:127]
    s_nop 0
    v_permlane16_swap_b32 v202, v203
    v_mfma_f32_16x16x32_bf16 v[128:131], a[24:27], v[88:91], v[128:131]
    v_max_f32 v202, v202, v203
    v_mov_b32 v203, v202
    v_mfma_f32_16x16x32_bf16 v[120:123], a[92:95], v[92:95], v[120:123]
    ds_read_b128 v[88:91], v16 offset:33536
    v_mfma_f32_16x16x32_bf16 v[124:127], v[92:95], a[156:159], v[124:127]
    v_permlane32_swap_b32 v202, v203
    v_mfma_f32_16x16x32_bf16 v[128:131], a[28:31], v[92:95], v[128:131]
    v_max_f32 v202, v202, v203
    s_waitcnt vmcnt(13)
    s_barrier
    s_waitcnt lgkmcnt(5)
    v_mfma_f32_16x16x32_bf16 v[120:123], a[96:99], v[64:67], v[120:123]
    ds_read_b128 v[92:95], v17 offset:33536
    v_mul_f32 v202, 0xbeb8aa3b, v202
    v_fma_f32 v200, v200, s73, v202
    v_mfma_f32_16x16x32_bf16 v[124:127], v[64:67], a[160:163], v[124:127]
    buffer_load_dwordx4 v52, s[44:47], s91 offen offset:0 lds
    v_fma_f32 v201, v201, s73, v202
    v_mfma_f32_16x16x32_bf16 v[128:131], a[32:35], v[64:67], v[128:131]
    buffer_load_dwordx4 v53, s[44:47], s91 offen offset:1024 lds
    v_mfma_f32_16x16x32_bf16 v[120:123], a[100:103], v[68:71], v[120:123]
    ds_read_b128 v[64:67], v14 offset:49152
    v_exp_f32 v200, v200
    v_mfma_f32_16x16x32_bf16 v[124:127], v[68:71], a[164:167], v[124:127]
    v_exp_f32 v201, v201
    v_mfma_f32_16x16x32_bf16 v[128:131], a[36:39], v[68:71], v[128:131]
    buffer_load_dwordx4 v54, s[44:47], s91 offen offset:2048 lds
    s_waitcnt lgkmcnt(5)
    v_mfma_f32_16x16x32_bf16 v[120:123], a[104:107], v[72:75], v[120:123]
    ds_read_b128 v[68:71], v15 offset:49152
    s_add_u32 m0, s88, 94208
    s_add_u32 s91, s22, 88064
    v_mfma_f32_16x16x32_bf16 v[124:127], v[72:75], a[168:171], v[124:127]
    v_cvt_pk_bf16_f32 v200, v200, v200
    v_cvt_pk_bf16_f32 v201, v201, v201
    v_mfma_f32_16x16x32_bf16 v[128:131], a[40:43], v[72:75], v[128:131]
    v_and_b32 v204, v200, v48
    v_and_b32 v205, v201, v49
    v_mfma_f32_16x16x32_bf16 v[120:123], a[108:111], v[76:79], v[120:123]
    ds_read_b128 v[72:75], v16 offset:49152
    v_and_b32 v206, v200, v50
    v_and_b32 v207, v201, v51
    v_mfma_f32_16x16x32_bf16 v[124:127], v[76:79], a[172:175], v[124:127]
    buffer_load_dwordx4 v52, s[44:47], s91 offen offset:0 lds
    v_mfma_f32_16x16x32_bf16 v[128:131], a[44:47], v[76:79], v[128:131]
    v_mfma_f32_16x16x32_bf16 v[212:215], v[180:183], v[204:207], 0
    buffer_load_dwordx4 v53, s[44:47], s91 offen offset:1024 lds
    v_mfma_f32_16x16x32_bf16 v[208:211], v[166:169], v[204:207], 0
    s_waitcnt lgkmcnt(5)
    v_mfma_f32_16x16x32_bf16 v[120:123], a[112:115], v[80:83], v[120:123]
    ds_read_b128 v[76:79], v17 offset:49152
    v_mfma_f32_16x16x32_bf16 v[124:127], v[80:83], a[176:179], v[124:127]
    v_mfma_f32_16x16x32_bf16 v[128:131], a[48:51], v[80:83], v[128:131]
    buffer_load_dwordx4 v54, s[44:47], s91 offen offset:2048 lds
    s_add_u32 m0, s88, 106496
    v_mfma_f32_16x16x32_bf16 v[120:123], a[116:119], v[84:87], v[120:123]
    ds_read_b128 v[80:83], v14 offset:49408
    s_add_u32 s91, s22, 176128
    v_mfma_f32_16x16x32_bf16 v[124:127], v[84:87], a[180:183], v[124:127]
    v_rcp_f32 v212, v212
    v_mfma_f32_16x16x32_bf16 v[128:131], a[52:55], v[84:87], v[128:131]
    v_mul_f32 v208, v208, v212
    s_waitcnt lgkmcnt(5)
    v_mfma_f32_16x16x32_bf16 v[120:123], a[120:123], v[88:91], v[120:123]
    ds_read_b128 v[84:87], v15 offset:49408
    v_mul_f32 v209, v209, v212
    v_mul_f32 v210, v210, v212
    v_mfma_f32_16x16x32_bf16 v[124:127], v[88:91], a[184:187], v[124:127]
    v_mul_f32 v211, v211, v212
    v_cvt_pk_bf16_f32 v216, v208, v209
    v_mfma_f32_16x16x32_bf16 v[128:131], a[56:59], v[88:91], v[128:131]
    v_cvt_pk_bf16_f32 v217, v210, v211
    v_mfma_f32_16x16x32_bf16 v[120:123], a[124:127], v[92:95], v[120:123]
    ds_read_b128 v[88:91], v16 offset:49408
    v_mfma_f32_16x16x32_bf16 v[124:127], v[92:95], a[188:191], v[124:127]
    v_mfma_f32_16x16x32_bf16 v[128:131], a[60:63], v[92:95], v[128:131]
    s_waitcnt lgkmcnt(5)
    v_mfma_f32_16x16x32_bf16 v[132:135], a[64:67], v[64:67], 0
    ds_read_b128 v[92:95], v17 offset:49408
    v_mfma_f32_16x16x32_bf16 v[136:139], v[64:67], a[128:131], 0
    v_mfma_f32_16x16x32_bf16 v[140:143], a[0:3], v[64:67], 0
    v_mfma_f32_16x16x32_bf16 v[132:135], a[68:71], v[68:71], v[132:135]
    ds_read_b128 v[64:67], v14 offset:49664
    v_cvt_pk_bf16_f32 v160, v120, v121
    v_cvt_pk_bf16_f32 v161, v122, v123
    v_cvt_pk_bf16_f32 v176, v128, v129
    v_cvt_pk_bf16_f32 v177, v130, v131
    v_mfma_f32_16x16x32_bf16 v[136:139], v[68:71], a[132:135], v[136:139]
    v_cvt_pk_bf16_f32 v170, v124, v125
    v_cvt_pk_bf16_f32 v171, v126, v127
    v_mfma_f32_16x16x16_bf16 v[184:187], v[158:159], v[176:177], 0
    v_mfma_f32_16x16x16_bf16 v[188:191], v[160:161], v[176:177], 0
    v_mfma_f32_16x16x32_bf16 v[140:143], a[4:7], v[68:71], v[140:143]
    s_waitcnt lgkmcnt(5)
    v_mfma_f32_16x16x32_bf16 v[132:135], a[72:75], v[72:75], v[132:135]
    ds_read_b128 v[68:71], v15 offset:49664
    v_mfma_f32_16x16x32_bf16 v[136:139], v[72:75], a[136:139], v[136:139]
    v_mfma_f32_16x16x32_bf16 v[140:143], a[8:11], v[72:75], v[140:143]
    s_nop 1
    v_cndmask_b32 v184, v184, v188, s[4:5]
    v_cndmask_b32 v185, v185, v189, s[6:7]
    v_cndmask_b32 v186, v186, v190, s[8:9]
    v_mfma_f32_16x16x32_bf16 v[132:135], a[76:79], v[76:79], v[132:135]
    ds_read_b128 v[72:75], v16 offset:49664
    v_cndmask_b32 v187, v187, v191, s[10:11]
    v_cndmask_b32 v184, v184, v185, s[12:13]
    v_cndmask_b32 v185, v186, v187, s[12:13]
    v_max_f32 v186, v184, v185
    v_mfma_f32_16x16x32_bf16 v[136:139], v[76:79], a[140:143], v[136:139]
    v_mov_b32 v187, v186
    v_mfma_f32_16x16x32_bf16 v[140:143], a[12:15], v[76:79], v[140:143]
    s_nop 0
    v_permlane16_swap_b32 v186, v187
    s_waitcnt lgkmcnt(5)
    v_mfma_f32_16x16x32_bf16 v[132:135], a[80:83], v[80:83], v[132:135]
    ds_read_b128 v[76:79], v17 offset:49664
    v_max_f32 v186, v186, v187
    v_mov_b32 v187, v186
    v_mfma_f32_16x16x32_bf16 v[136:139], v[80:83], a[144:147], v[136:139]
    s_nop 0
    v_permlane32_swap_b32 v186, v187
    v_max_f32 v186, v186, v187
    v_mfma_f32_16x16x32_bf16 v[140:143], a[16:19], v[80:83], v[140:143]
    v_mul_f32 v186, 0xbeb8aa3b, v186
    v_fma_f32 v184, v184, s73, v186
    v_fma_f32 v185, v185, s73, v186
    v_mfma_f32_16x16x32_bf16 v[132:135], a[84:87], v[84:87], v[132:135]
    ds_read_b128 v[80:83], v14 offset:49920
    v_exp_f32 v184, v184
    v_exp_f32 v185, v185
    v_mfma_f32_16x16x32_bf16 v[136:139], v[84:87], a[148:151], v[136:139]
    buffer_load_dwordx4 v52, s[44:47], s91 offen offset:0 lds
    v_cvt_pk_bf16_f32 v184, v184, v184
    v_cvt_pk_bf16_f32 v185, v185, v185
    v_mfma_f32_16x16x32_bf16 v[140:143], a[20:23], v[84:87], v[140:143]
    v_and_b32 v188, v184, v48
    v_and_b32 v189, v185, v49
    s_waitcnt lgkmcnt(5)
    v_mfma_f32_16x16x32_bf16 v[132:135], a[88:91], v[88:91], v[132:135]
    ds_read_b128 v[84:87], v15 offset:49920
    v_and_b32 v190, v184, v50
    v_and_b32 v191, v185, v51
    v_mfma_f32_16x16x32_bf16 v[136:139], v[88:91], a[152:155], v[136:139]
    buffer_load_dwordx4 v53, s[44:47], s91 offen offset:1024 lds
    v_mfma_f32_16x16x32_bf16 v[196:199], v[180:183], v[188:191], 0
    v_mfma_f32_16x16x32_bf16 v[192:195], v[168:171], v[188:191], 0
    v_mfma_f32_16x16x32_bf16 v[140:143], a[24:27], v[88:91], v[140:143]
    buffer_load_dwordx4 v54, s[44:47], s91 offen offset:2048 lds
    s_add_u32 m0, s88, 118784
    s_add_u32 s91, s22, 264192
    v_mfma_f32_16x16x32_bf16 v[132:135], a[92:95], v[92:95], v[132:135]
    ds_read_b128 v[88:91], v16 offset:49920
    v_mfma_f32_16x16x32_bf16 v[136:139], v[92:95], a[156:159], v[136:139]
    v_mfma_f32_16x16x32_bf16 v[140:143], a[28:31], v[92:95], v[140:143]
    s_waitcnt vmcnt(9)
    s_barrier
    s_waitcnt lgkmcnt(5)
    v_mfma_f32_16x16x32_bf16 v[132:135], a[96:99], v[64:67], v[132:135]
    ds_read_b128 v[92:95], v17 offset:49920
    v_rcp_f32 v196, v196
    s_nop 0
    v_mul_f32 v192, v192, v196
    v_mul_f32 v193, v193, v196
    v_mfma_f32_16x16x32_bf16 v[136:139], v[64:67], a[160:163], v[136:139]
    buffer_load_dwordx4 v52, s[44:47], s91 offen offset:0 lds
    v_mul_f32 v194, v194, v196
    v_mul_f32 v195, v195, v196
    v_mfma_f32_16x16x32_bf16 v[140:143], a[32:35], v[64:67], v[140:143]
    buffer_load_dwordx4 v53, s[44:47], s91 offen offset:1024 lds
    v_cvt_pk_bf16_f32 v218, v192, v193
    v_cvt_pk_bf16_f32 v219, v194, v195
    v_mfma_f32_16x16x32_bf16 v[132:135], a[100:103], v[68:71], v[132:135]
    ds_read_b128 v[64:67], v10 offset:0
    v_mfma_f32_16x16x32_bf16 v[136:139], v[68:71], a[164:167], v[136:139]
    buffer_load_dwordx4 v54, s[44:47], s91 offen offset:2048 lds
    s_add_u32 m0, s88, 131072
    s_add_u32 s91, s22, 352256
    v_mfma_f32_16x16x32_bf16 v[140:143], a[36:39], v[68:71], v[140:143]
    v_permlane16_swap_b32 v216, v218
    s_waitcnt lgkmcnt(5)
    v_mfma_f32_16x16x32_bf16 v[132:135], a[104:107], v[72:75], v[132:135]
    ds_read_b128 v[68:71], v11 offset:0
    v_permlane16_swap_b32 v217, v219
    v_mfma_f32_16x16x32_bf16 v[136:139], v[72:75], a[168:171], v[136:139]
    buffer_store_dwordx4 v[216:219], v37, s[52:55], s16 offen sc1
    v_mfma_f32_16x16x32_bf16 v[140:143], a[40:43], v[72:75], v[140:143]
    v_mfma_f32_16x16x32_bf16 v[132:135], a[108:111], v[76:79], v[132:135]
    ds_read_b128 v[72:75], v12 offset:0
    v_mfma_f32_16x16x32_bf16 v[136:139], v[76:79], a[172:175], v[136:139]
    v_mfma_f32_16x16x32_bf16 v[140:143], a[44:47], v[76:79], v[140:143]
    s_waitcnt lgkmcnt(5)
    v_mfma_f32_16x16x32_bf16 v[132:135], a[112:115], v[80:83], v[132:135]
    ds_read_b128 v[76:79], v13 offset:0
    v_mfma_f32_16x16x32_bf16 v[136:139], v[80:83], a[176:179], v[136:139]
    v_mfma_f32_16x16x32_bf16 v[140:143], a[48:51], v[80:83], v[140:143]
    v_mfma_f32_16x16x32_bf16 v[132:135], a[116:119], v[84:87], v[132:135]
    ds_read_b128 v[80:83], v10 offset:256
    v_mfma_f32_16x16x32_bf16 v[136:139], v[84:87], a[180:183], v[136:139]
    v_mfma_f32_16x16x32_bf16 v[140:143], a[52:55], v[84:87], v[140:143]
    s_waitcnt lgkmcnt(5)
    v_mfma_f32_16x16x32_bf16 v[132:135], a[120:123], v[88:91], v[132:135]
    ds_read_b128 v[84:87], v11 offset:256
    v_mfma_f32_16x16x32_bf16 v[136:139], v[88:91], a[184:187], v[136:139]
    v_mfma_f32_16x16x32_bf16 v[140:143], a[56:59], v[88:91], v[140:143]
    v_mfma_f32_16x16x32_bf16 v[132:135], a[124:127], v[92:95], v[132:135]
    ds_read_b128 v[88:91], v12 offset:256
    v_mfma_f32_16x16x32_bf16 v[136:139], v[92:95], a[188:191], v[136:139]
    v_mfma_f32_16x16x32_bf16 v[140:143], a[60:63], v[92:95], v[140:143]
    s_waitcnt lgkmcnt(5)
    v_mfma_f32_16x16x32_bf16 v[144:147], a[64:67], v[64:67], 0
    ds_read_b128 v[92:95], v13 offset:256
    v_mfma_f32_16x16x32_bf16 v[152:155], a[0:3], v[64:67], 0
    v_mfma_f32_16x16x32_bf16 v[144:147], a[68:71], v[68:71], v[144:147]
    ds_read_b128 v[64:67], v10 offset:512
    v_mfma_f32_16x16x32_bf16 v[152:155], a[4:7], v[68:71], v[152:155]
    v_cvt_pk_bf16_f32 v162, v132, v133
    s_barrier
    s_waitcnt lgkmcnt(5)
    v_mfma_f32_16x16x32_bf16 v[144:147], a[72:75], v[72:75], v[144:147]
    ds_read_b128 v[68:71], v11 offset:512
    v_cvt_pk_bf16_f32 v163, v134, v135
    v_cvt_pk_bf16_f32 v176, v140, v141
    v_mfma_f32_16x16x32_bf16 v[152:155], a[8:11], v[72:75], v[152:155]
    buffer_load_dwordx4 v52, s[44:47], s91 offen offset:0 lds
    v_cvt_pk_bf16_f32 v177, v142, v143
    v_mfma_f32_16x16x32_bf16 v[144:147], a[76:79], v[76:79], v[144:147]
    ds_read_b128 v[72:75], v12 offset:512
    v_cvt_pk_bf16_f32 v172, v136, v137
    v_cvt_pk_bf16_f32 v173, v138, v139
    v_mfma_f32_16x16x32_bf16 v[152:155], a[12:15], v[76:79], v[152:155]
    buffer_load_dwordx4 v53, s[44:47], s91 offen offset:1024 lds
    s_waitcnt lgkmcnt(5)
    v_mfma_f32_16x16x32_bf16 v[144:147], a[80:83], v[80:83], v[144:147]
    ds_read_b128 v[76:79], v13 offset:512
    v_mfma_f32_16x16x16_bf16 v[200:203], v[160:161], v[176:177], 0
    v_mfma_f32_16x16x16_bf16 v[204:207], v[162:163], v[176:177], 0
    v_mfma_f32_16x16x32_bf16 v[152:155], a[16:19], v[80:83], v[152:155]
    buffer_load_dwordx4 v54, s[44:47], s91 offen offset:2048 lds
    s_add_u32 m0, s88, 32768
    v_mfma_f32_16x16x32_bf16 v[144:147], a[84:87], v[84:87], v[144:147]
    ds_read_b128 v[80:83], v10 offset:768
    s_add_u32 s91, s22, 440320
    v_mfma_f32_16x16x32_bf16 v[152:155], a[20:23], v[84:87], v[152:155]
    s_waitcnt lgkmcnt(5)
    v_mfma_f32_16x16x32_bf16 v[144:147], a[88:91], v[88:91], v[144:147]
    ds_read_b128 v[84:87], v11 offset:768
    v_mfma_f32_16x16x32_bf16 v[152:155], a[24:27], v[88:91], v[152:155]
    buffer_load_dwordx4 v52, s[44:47], s91 offen offset:0 lds
    v_cndmask_b32 v200, v200, v204, s[4:5]
    v_mfma_f32_16x16x32_bf16 v[144:147], a[92:95], v[92:95], v[144:147]
    ds_read_b128 v[88:91], v12 offset:768
    v_cndmask_b32 v201, v201, v205, s[6:7]
    v_cndmask_b32 v202, v202, v206, s[8:9]
    v_mfma_f32_16x16x32_bf16 v[152:155], a[28:31], v[92:95], v[152:155]
    v_cndmask_b32 v203, v203, v207, s[10:11]
    s_waitcnt lgkmcnt(5)
    v_mfma_f32_16x16x32_bf16 v[144:147], a[96:99], v[64:67], v[144:147]
    ds_read_b128 v[92:95], v13 offset:768
    v_cndmask_b32 v200, v200, v201, s[12:13]
    v_cndmask_b32 v201, v202, v203, s[12:13]
    v_mfma_f32_16x16x32_bf16 v[152:155], a[32:35], v[64:67], v[152:155]
    buffer_load_dwordx4 v53, s[44:47], s91 offen offset:1024 lds
    v_max_f32 v202, v200, v201
    v_mfma_f32_16x16x32_bf16 v[144:147], a[100:103], v[68:71], v[144:147]
    ds_read_b128 v[64:67], v10 offset:0
    v_mov_b32 v203, v202
    v_mfma_f32_16x16x32_bf16 v[152:155], a[36:39], v[68:71], v[152:155]
    s_waitcnt lgkmcnt(5)
    v_mfma_f32_16x16x32_bf16 v[144:147], a[104:107], v[72:75], v[144:147]
    ds_read_b128 v[68:71], v11 offset:0
    v_permlane16_swap_b32 v202, v203
    v_mfma_f32_16x16x32_bf16 v[152:155], a[40:43], v[72:75], v[152:155]
    buffer_load_dwordx4 v54, s[44:47], s91 offen offset:2048 lds
    s_add_u32 m0, s88, 45056
    v_mfma_f32_16x16x32_bf16 v[144:147], a[108:111], v[76:79], v[144:147]
    ds_read_b128 v[72:75], v12 offset:0
    s_add_u32 s91, s22, 528384
    v_max_f32 v202, v202, v203
    v_mfma_f32_16x16x32_bf16 v[152:155], a[44:47], v[76:79], v[152:155]
    v_mov_b32 v203, v202
    s_waitcnt lgkmcnt(5)
    v_mfma_f32_16x16x32_bf16 v[144:147], a[112:115], v[80:83], v[144:147]
    ds_read_b128 v[76:79], v13 offset:0
    v_mfma_f32_16x16x32_bf16 v[152:155], a[48:51], v[80:83], v[152:155]
    v_permlane32_swap_b32 v202, v203
    v_mfma_f32_16x16x32_bf16 v[144:147], a[116:119], v[84:87], v[144:147]
    ds_read_b128 v[80:83], v10 offset:256
    v_max_f32 v202, v202, v203
    v_mul_f32 v202, 0xbeb8aa3b, v202
    v_mfma_f32_16x16x32_bf16 v[152:155], a[52:55], v[84:87], v[152:155]
    v_fma_f32 v200, v200, s73, v202
    s_waitcnt lgkmcnt(5)
    v_mfma_f32_16x16x32_bf16 v[144:147], a[120:123], v[88:91], v[144:147]
    ds_read_b128 v[84:87], v11 offset:256
    v_fma_f32 v201, v201, s73, v202
    v_mfma_f32_16x16x32_bf16 v[152:155], a[56:59], v[88:91], v[152:155]
    v_exp_f32 v200, v200
    v_mfma_f32_16x16x32_bf16 v[144:147], a[124:127], v[92:95], v[144:147]
    ds_read_b128 v[88:91], v12 offset:256
    v_exp_f32 v201, v201
    v_mfma_f32_16x16x32_bf16 v[152:155], a[60:63], v[92:95], v[152:155]
    v_cvt_pk_bf16_f32 v200, v200, v200
    v_cvt_pk_bf16_f32 v201, v201, v201
    v_and_b32 v204, v200, v48
    v_and_b32 v205, v201, v49
    v_and_b32 v206, v200, v50
    v_and_b32 v207, v201, v51
    s_nop 1
    v_mfma_f32_16x16x32_bf16 v[212:215], v[180:183], v[204:207], 0
    v_mfma_f32_16x16x32_bf16 v[208:211], v[170:173], v[204:207], 0
    s_nop 6
    v_rcp_f32 v212, v212
    s_nop 0
    v_mul_f32 v208, v208, v212
    v_mul_f32 v209, v209, v212
    v_mul_f32 v210, v210, v212
    v_mul_f32 v211, v211, v212
    v_cvt_pk_bf16_f32 v220, v208, v209
    v_cvt_pk_bf16_f32 v221, v210, v211
    s_waitcnt lgkmcnt(5)
    v_mfma_f32_16x16x32_bf16 v[148:151], v[64:67], a[128:131], 0
    ds_read_b128 v[92:95], v13 offset:256
    v_mfma_f32_16x16x32_bf16 v[148:151], v[68:71], a[132:135], v[148:151]
    ds_read_b128 v[64:67], v10 offset:512
    s_waitcnt lgkmcnt(5)
    v_mfma_f32_16x16x32_bf16 v[148:151], v[72:75], a[136:139], v[148:151]
    ds_read_b128 v[68:71], v11 offset:512
    v_mfma_f32_16x16x32_bf16 v[148:151], v[76:79], a[140:143], v[148:151]
    ds_read_b128 v[72:75], v12 offset:512
    v_cvt_pk_bf16_f32 v164, v144, v145
    v_cvt_pk_bf16_f32 v165, v146, v147
    s_waitcnt lgkmcnt(5)
    v_mfma_f32_16x16x32_bf16 v[148:151], v[80:83], a[144:147], v[148:151]
    ds_read_b128 v[76:79], v13 offset:512
    v_cvt_pk_bf16_f32 v176, v152, v153
    v_cvt_pk_bf16_f32 v177, v154, v155
    s_waitcnt vmcnt(6)
    s_barrier
    s_cmp_lg_u32 s3, 0
    s_cbranch_scc1 Lpub_17
    s_add_u32 s20, s66, 2
    v_mov_b32 v60, s20
    s_mov_b64 exec, 1
    s_cmp_eq_u32 s67, 1
    s_cbranch_scc1 Lpub_18
    buffer_store_dword v60, v41, s[52:55], s17 offen offset:32 sc1
    s_mov_b64 exec, -1
    s_branch Lpub_17
Lpub_18:
    buffer_store_dword v60, v41, s[52:55], s17 offen offset:32
    s_mov_b64 exec, -1
Lpub_17:
    v_mfma_f32_16x16x32_bf16 v[148:151], v[84:87], a[148:151], v[148:151]
    ds_read_b128 v[80:83], v10 offset:768
    s_waitcnt lgkmcnt(5)
    v_mfma_f32_16x16x32_bf16 v[148:151], v[88:91], a[152:155], v[148:151]
    ds_read_b128 v[84:87], v11 offset:768
    v_mfma_f32_16x16x16_bf16 v[184:187], v[162:163], v[176:177], 0
    buffer_load_dwordx4 v52, s[44:47], s91 offen offset:0 lds
    v_mfma_f32_16x16x16_bf16 v[188:191], v[164:165], v[176:177], 0
    v_mfma_f32_16x16x32_bf16 v[148:151], v[92:95], a[156:159], v[148:151]
    ds_read_b128 v[88:91], v12 offset:768
    s_waitcnt lgkmcnt(5)
    v_mfma_f32_16x16x32_bf16 v[148:151], v[64:67], a[160:163], v[148:151]
    ds_read_b128 v[92:95], v13 offset:768
    v_mfma_f32_16x16x32_bf16 v[148:151], v[68:71], a[164:167], v[148:151]
    buffer_load_dwordx4 v53, s[44:47], s91 offen offset:1024 lds
    s_waitcnt lgkmcnt(4)
    v_mfma_f32_16x16x32_bf16 v[148:151], v[72:75], a[168:171], v[148:151]
    v_cndmask_b32 v184, v184, v188, s[4:5]
    v_cndmask_b32 v185, v185, v189, s[6:7]
    v_cndmask_b32 v186, v186, v190, s[8:9]
    v_mfma_f32_16x16x32_bf16 v[148:151], v[76:79], a[172:175], v[148:151]
    v_cndmask_b32 v187, v187, v191, s[10:11]
    v_cndmask_b32 v184, v184, v185, s[12:13]
    v_cndmask_b32 v185, v186, v187, s[12:13]
    s_waitcnt lgkmcnt(2)
    v_mfma_f32_16x16x32_bf16 v[148:151], v[80:83], a[176:179], v[148:151]
    buffer_load_dwordx4 v54, s[44:47], s91 offen offset:2048 lds
    v_max_f32 v186, v184, v185
    v_mov_b32 v187, v186
    v_mfma_f32_16x16x32_bf16 v[148:151], v[84:87], a[180:183], v[148:151]
    s_waitcnt lgkmcnt(0)
    v_mfma_f32_16x16x32_bf16 v[148:151], v[88:91], a[184:187], v[148:151]
    v_permlane16_swap_b32 v186, v187
    v_max_f32 v186, v186, v187
    v_mfma_f32_16x16x32_bf16 v[148:151], v[92:95], a[188:191], v[148:151]
    v_mov_b32 v187, v186
    s_nop 1
    v_permlane32_swap_b32 v186, v187
    v_max_f32 v186, v186, v187
    v_mul_f32 v186, 0xbeb8aa3b, v186
    v_fma_f32 v184, v184, s73, v186
    v_fma_f32 v185, v185, s73, v186
    v_exp_f32 v184, v184
    v_exp_f32 v185, v185
    v_cvt_pk_bf16_f32 v184, v184, v184
    v_cvt_pk_bf16_f32 v185, v185, v185
    v_and_b32 v188, v184, v48
    v_and_b32 v189, v185, v49
    v_and_b32 v190, v184, v50
    v_and_b32 v191, v185, v51
    s_nop 1
    v_mfma_f32_16x16x32_bf16 v[196:199], v[180:183], v[188:191], 0
    v_cvt_pk_bf16_f32 v174, v148, v149
    v_cvt_pk_bf16_f32 v175, v150, v151
    s_nop 1
    v_mfma_f32_16x16x32_bf16 v[192:195], v[172:175], v[188:191], 0
    s_nop 2
    v_rcp_f32 v196, v196
    s_nop 3
    v_mul_f32 v192, v192, v196
    v_mul_f32 v193, v193, v196
    v_mul_f32 v194, v194, v196
    v_mul_f32 v195, v195, v196
    v_cvt_pk_bf16_f32 v222, v192, v193
    v_cvt_pk_bf16_f32 v223, v194, v195
    s_nop 0
    v_permlane16_swap_b32 v220, v222
    v_permlane16_swap_b32 v221, v223
    buffer_store_dwordx4 v[220:223], v37, s[52:55], s74 offen sc1
    v_subrev_u32 v10, 73728, v34
    v_subrev_u32 v11, 73728, v35
    v_subrev_u32 v12, 73728, v36
    s_barrier
    s_add_u32 s73, s16, 176128
    buffer_load_dword v40, v39, s[52:55], s17 offen offset:32 sc1
    s_add_u32 m0, s88, 45056
    s_add_u32 s91, s22, 528384
    s_add_u32 m0, s88, 65536
    s_add_u32 s91, s22, 616448
    buffer_load_dwordx4 v52, s[44:47], s91 offen offset:0 lds
    s_add_u32 s75, s16, 208896
    buffer_load_dwordx4 v53, s[44:47], s91 offen offset:1024 lds
    ds_read_b64 v[240:241], v33 offset:0
    buffer_load_dwordx4 v54, s[44:47], s91 offen offset:2048 lds
    ds_read_b64 v[242:243], v33 offset:2048
    ds_read_b64 v[244:245], v33 offset:4096
    ds_read_b64 v[246:247], v33 offset:6144
    ds_read_b64_tr_b16 a[0:1], v34 offset:0
    ds_read_b64_tr_b16 a[2:3], v34 offset:1536
    ds_read_b64_tr_b16 a[64:65], v35 offset:0
    ds_read_b64_tr_b16 a[66:67], v35 offset:1536
    ds_read_b64_tr_b16 a[128:129], v36 offset:0
    ds_read_b64_tr_b16 a[130:131], v36 offset:1536
    ds_read_b64_tr_b16 a[4:5], v34 offset:12288
    ds_read_b64_tr_b16 a[6:7], v34 offset:13824
    ds_read_b64_tr_b16 a[68:69], v35 offset:12288
    ds_read_b64_tr_b16 a[70:71], v35 offset:13824
    ds_read_b64_tr_b16 a[132:133], v36 offset:12288
    ds_read_b64_tr_b16 a[134:135], v36 offset:13824
    ds_read_b64_tr_b16 a[8:9], v34 offset:24576
    ds_read_b64_tr_b16 a[10:11], v34 offset:26112
    ds_read_b64_tr_b16 a[72:73], v35 offset:24576
    ds_read_b64_tr_b16 a[74:75], v35 offset:26112
    ds_read_b64_tr_b16 a[136:137], v36 offset:24576
    ds_read_b64_tr_b16 a[138:139], v36 offset:26112
    ds_read_b64_tr_b16 a[12:13], v34 offset:36864
    ds_read_b64_tr_b16 a[14:15], v34 offset:38400
    ds_read_b64_tr_b16 a[76:77], v35 offset:36864
    ds_read_b64_tr_b16 a[78:79], v35 offset:38400
    ds_read_b64_tr_b16 a[140:141], v36 offset:36864
    ds_read_b64_tr_b16 a[142:143], v36 offset:38400
    s_waitcnt lgkmcnt(15)
    v_lshlrev_b32 v112, 16, v240
    v_and_b32 v113, 0xffff0000, v240
    v_lshlrev_b32 v114, 16, v241
    v_and_b32 v115, 0xffff0000, v241
    v_lshlrev_b32 v116, 16, v242
    v_and_b32 v117, 0xffff0000, v242
    v_lshlrev_b32 v118, 16, v243
    v_and_b32 v119, 0xffff0000, v243
    v_lshlrev_b32 v120, 16, v244
    v_and_b32 v121, 0xffff0000, v244
    v_lshlrev_b32 v122, 16, v245
    v_and_b32 v123, 0xffff0000, v245
    v_lshlrev_b32 v124, 16, v246
    v_and_b32 v125, 0xffff0000, v246
    v_lshlrev_b32 v126, 16, v247
    v_and_b32 v127, 0xffff0000, v247
    s_mul_i32 s89, s3, 360448
    s_lshl_b32 s69, s65, 7
    s_add_u32 s89, s89, s69
    s_lshr_b32 s69, s3, 1
    s_and_b32 s69, s69, s3
    s_lshl_b32 s69, s69, 15
    s_sub_u32 s78, s89, s69
    s_add_u32 s78, s78, 327680
    s_add_u32 s76, s97, 3072
    v_add_u32 v19, s25, v19
    v_add_u32 v20, s25, v20
    v_add_u32 v21, s25, v21
    v_add_u32 v22, s25, v22
    v_subrev_u32 v14, 65536, v19
    v_subrev_u32 v15, 65536, v20
    v_subrev_u32 v16, 65536, v21
    v_subrev_u32 v17, 65536, v22
    s_mul_i32 s69, s3, 1536
    s_add_u32 s69, s69, 152576
    v_add_u32 v29, s69, v43
    s_min_u32 s69, s3, 2
    s_lshl_b32 s79, s69, 10
    s_lshl_b32 s69, s69, 9
    s_add_u32 s69, s69, 152576
    v_add_u32 v30, s69, v43
    s_mul_i32 s69, s65, 3072
    s_add_u32 s79, s79, s69
    s_add_u32 s79, s79, s86
    s_add_u32 s79, s79, 241664
    s_waitcnt vmcnt(8)
    s_waitcnt lgkmcnt(0)
    s_barrier
    ds_read_b64_tr_b16 a[16:17], v34 offset:49152
    s_add_u32 m0, s88, 81920
    s_add_u32 s91, s22, 704512
    buffer_load_dwordx4 v52, s[44:47], s91 offen offset:0 lds
    ds_read_b64_tr_b16 a[18:19], v34 offset:50688
    buffer_load_dwordx4 v53, s[44:47], s91 offen offset:1024 lds
    ds_read_b64_tr_b16 a[80:81], v35 offset:49152
    buffer_load_dwordx4 v54, s[44:47], s91 offen offset:2048 lds
    ds_read_b64_tr_b16 a[82:83], v35 offset:50688
    ds_read_b64_tr_b16 a[144:145], v36 offset:49152
    ds_read_b64_tr_b16 a[146:147], v36 offset:50688
    ds_read_b64_tr_b16 a[20:21], v10 offset:24576
    ds_read_b64_tr_b16 a[22:23], v10 offset:26112
    ds_read_b64_tr_b16 a[84:85], v11 offset:24576
    s_add_u32 m0, s88, 94208
    s_add_u32 s91, s22, 792576
    buffer_load_dwordx4 v52, s[44:47], s91 offen offset:0 lds
    ds_read_b64_tr_b16 a[86:87], v11 offset:26112
    ds_read_b64_tr_b16 a[148:149], v12 offset:24576
    ds_read_b64_tr_b16 a[150:151], v12 offset:26112
    ds_read_b128 v[184:187], v44 offset:0
    ds_read_b128 v[188:191], v44 offset:64
    s_waitcnt lgkmcnt(1)
    v_mfma_f32_16x16x32_bf16 v[128:131], v[184:187], a[0:3], 0
    buffer_load_dwordx4 v53, s[44:47], s91 offen offset:1024 lds
    v_mfma_f32_16x16x32_bf16 v[132:135], v[184:187], a[64:67], 0
    buffer_load_dwordx4 v54, s[44:47], s91 offen offset:2048 lds
    s_add_u32 m0, s88, 106496
    v_mfma_f32_16x16x32_bf16 v[136:139], v[184:187], a[128:131], 0
    s_add_u32 s91, s22, 880640
    s_waitcnt lgkmcnt(0)
    v_mfma_f32_16x16x32_bf16 v[128:131], v[188:191], a[4:7], v[128:131]
    v_mfma_f32_16x16x32_bf16 v[132:135], v[188:191], a[68:71], v[132:135]
    v_mfma_f32_16x16x32_bf16 v[136:139], v[188:191], a[132:135], v[136:139]
    s_add_u32 s20, s66, 2
    s_waitcnt vmcnt(9)
    v_cmp_ne_u32 s[28:29], s20, v40
    s_nop 0
    s_cmp_eq_u64 s[28:29], 0
    s_cbranch_scc1 Lwok_20
Lw_19:
    buffer_load_dword v40, v39, s[52:55], s17 offen offset:32 sc1
    s_waitcnt vmcnt(0)
    v_cmp_ne_u32 s[28:29], s20, v40
    s_nop 0
    s_cmp_eq_u64 s[28:29], 0
    s_cbranch_scc1 Lwok_20
    s_add_u32 s85, s85, 1
    s_cmp_lt_u32 s85, 400000
    s_cbranch_scc1 Lw_19
Lwok_20:
    s_add_u32 s72, s86, s25
    s_add_u32 m0, s25, 0
    s_add_u32 s91, s72, 0
    buffer_load_dwordx4 v1, s[52:55], s91 offen offset:0 sc1 lds
    buffer_load_dwordx4 v1, s[52:55], s91 offen offset:1024 sc1 lds
    buffer_load_dwordx4 v1, s[52:55], s91 offen offset:2048 sc1 lds
    s_barrier
    s_cmp_lg_u32 s3, 0
    s_cbranch_scc1 Lpub_21
    s_add_u32 s20, s66, 3
    v_mov_b32 v60, s20
    s_mov_b64 exec, 1
    s_cmp_eq_u32 s67, 1
    s_cbranch_scc1 Lpub_22
    buffer_store_dword v60, v41, s[52:55], s17 offen offset:64 sc1
    s_mov_b64 exec, -1
    s_branch Lpub_21
Lpub_22:
    buffer_store_dword v60, v41, s[52:55], s17 offen offset:64
    s_mov_b64 exec, -1
Lpub_21:
    ds_read_b64_tr_b16 a[24:25], v10 offset:36864
    ds_read_b64_tr_b16 a[26:27], v10 offset:38400
    ds_read_b64_tr_b16 a[88:89], v11 offset:36864
    ds_read_b64_tr_b16 a[90:91], v11 offset:38400
    ds_read_b64_tr_b16 a[152:153], v12 offset:36864
    ds_read_b64_tr_b16 a[154:155], v12 offset:38400
    ds_read_b128 v[184:187], v44 offset:128
    ds_read_b128 v[188:191], v44 offset:192
    s_waitcnt lgkmcnt(1)
    v_mfma_f32_16x16x32_bf16 v[128:131], v[184:187], a[8:11], v[128:131]
    v_mfma_f32_16x16x32_bf16 v[132:135], v[184:187], a[72:75], v[132:135]
    v_mfma_f32_16x16x32_bf16 v[136:139], v[184:187], a[136:139], v[136:139]
    s_waitcnt lgkmcnt(0)
    v_mfma_f32_16x16x32_bf16 v[128:131], v[188:191], a[12:15], v[128:131]
    v_mfma_f32_16x16x32_bf16 v[132:135], v[188:191], a[76:79], v[132:135]
    buffer_load_dwordx4 v1, s[52:55], s91 offen offset:3072 sc1 lds
    s_add_u32 m0, s25, 16384
    v_mfma_f32_16x16x32_bf16 v[136:139], v[188:191], a[140:143], v[136:139]
    s_add_u32 s91, s72, 16384
    ds_read_b128 v[184:187], v44 offset:256
    ds_read_b128 v[188:191], v44 offset:320
    s_waitcnt lgkmcnt(1)
    v_mfma_f32_16x16x32_bf16 v[128:131], v[184:187], a[16:19], v[128:131]
    buffer_load_dwordx4 v1, s[52:55], s91 offen offset:0 sc1 lds
    v_mfma_f32_16x16x32_bf16 v[132:135], v[184:187], a[80:83], v[132:135]
    v_mfma_f32_16x16x32_bf16 v[136:139], v[184:187], a[144:147], v[136:139]
    s_waitcnt lgkmcnt(0)
    v_mfma_f32_16x16x32_bf16 v[128:131], v[188:191], a[20:23], v[128:131]
    v_mfma_f32_16x16x32_bf16 v[132:135], v[188:191], a[84:87], v[132:135]
    v_mfma_f32_16x16x32_bf16 v[136:139], v[188:191], a[148:151], v[136:139]
    buffer_load_dwordx4 v1, s[52:55], s91 offen offset:1024 sc1 lds
    ds_read_b128 v[184:187], v44 offset:384
    s_waitcnt lgkmcnt(0)
    v_mfma_f32_16x16x32_bf16 v[128:131], v[184:187], a[24:27], v[128:131]
    buffer_load_dwordx4 v1, s[52:55], s91 offen offset:2048 sc1 lds
    v_mfma_f32_16x16x32_bf16 v[132:135], v[184:187], a[88:91], v[132:135]
    buffer_load_dwordx4 v1, s[52:55], s91 offen offset:3072 sc1 lds
    s_add_u32 m0, s88, 106496
    v_mfma_f32_16x16x32_bf16 v[136:139], v[184:187], a[152:155], v[136:139]
    s_add_u32 s91, s22, 880640
    buffer_load_dword v40, v39, s[52:55], s17 offen offset:64 sc1
    s_waitcnt vmcnt(5)
    s_barrier
    ds_read_b128 v[64:67], v1 offset:0
    ds_read_b128 v[68:71], v1 offset:1024
    ds_read_b128 v[72:75], v1 offset:2048
    ds_read_b128 v[76:79], v1 offset:3072
    ds_read_b128 v[80:83], v1 offset:4096
    ds_read_b128 v[84:87], v1 offset:5120
    ds_read_b128 v[88:91], v1 offset:6144
    ds_read_b64_tr_b16 a[28:29], v10 offset:57344
    ds_read_b64_tr_b16 a[30:31], v10 offset:58880
    ds_read_b64_tr_b16 a[92:93], v11 offset:57344
    ds_read_b64_tr_b16 a[94:95], v11 offset:58880
    ds_read_b64_tr_b16 a[156:157], v12 offset:57344
    ds_read_b64_tr_b16 a[158:159], v12 offset:58880
    ds_read_b64_tr_b16 a[32:33], v34 offset:0
    ds_read_b64_tr_b16 a[34:35], v34 offset:1536
    ds_read_b64_tr_b16 a[96:97], v35 offset:0
    ds_read_b64_tr_b16 a[98:99], v35 offset:1536
    ds_read_b64_tr_b16 a[160:161], v36 offset:0
    ds_read_b64_tr_b16 a[162:163], v36 offset:1536
    s_waitcnt lgkmcnt(15)
    v_mfma_f32_16x16x32_bf16 v[96:99], a[192:195], v[64:67], 0
    ds_read_b128 v[92:95], v1 offset:7168
    s_add_u32 m0, s88, 106496
    v_mfma_f32_16x16x32_bf16 v[96:99], a[196:199], v[68:71], v[96:99]
    ds_read_b128 v[64:67], v1 offset:8192
    v_mfma_f32_16x16x32_bf16 v[96:99], a[200:203], v[72:75], v[96:99]
    ds_read_b128 v[68:71], v1 offset:9216
    s_add_u32 s91, s22, 880640
    v_mfma_f32_16x16x32_bf16 v[96:99], a[204:207], v[76:79], v[96:99]
    ds_read_b128 v[72:75], v1 offset:10240
    s_waitcnt lgkmcnt(15)
    v_mfma_f32_16x16x32_bf16 v[96:99], a[208:211], v[80:83], v[96:99]
    ds_read_b128 v[76:79], v1 offset:11264
    buffer_load_dwordx4 v52, s[44:47], s91 offen offset:0 lds
    v_mfma_f32_16x16x32_bf16 v[96:99], a[212:215], v[84:87], v[96:99]
    ds_read_b128 v[80:83], v1 offset:12288
    s_waitcnt lgkmcnt(5)
    v_mfma_f32_16x16x32_bf16 v[96:99], a[216:219], v[88:91], v[96:99]
    ds_read_b128 v[84:87], v1 offset:13312
    buffer_load_dwordx4 v53, s[44:47], s91 offen offset:1024 lds
    s_add_u32 s20, s66, 3
    s_waitcnt vmcnt(2)
    v_cmp_ne_u32 s[28:29], s20, v40
    s_nop 0
    s_cmp_eq_u64 s[28:29], 0
    s_cbranch_scc1 Lwok_24
Lw_23:
    buffer_load_dword v40, v39, s[52:55], s17 offen offset:64 sc1
    s_waitcnt vmcnt(0)
    v_cmp_ne_u32 s[28:29], s20, v40
    s_nop 0
    s_cmp_eq_u64 s[28:29], 0
    s_cbranch_scc1 Lwok_24
    s_add_u32 s85, s85, 1
    s_cmp_lt_u32 s85, 400000
    s_cbranch_scc1 Lw_23
Lwok_24:
    s_add_u32 m0, s25, 32768
    s_add_u32 s91, s72, 32768
    buffer_load_dwordx4 v1, s[52:55], s91 offen offset:0 sc1 lds
    buffer_load_dwordx4 v1, s[52:55], s91 offen offset:1024 sc1 lds
    buffer_load_dwordx4 v1, s[52:55], s91 offen offset:2048 sc1 lds
    buffer_load_dwordx4 v1, s[52:55], s91 offen offset:3072 sc1 lds
    v_mfma_f32_16x16x32_bf16 v[96:99], a[220:223], v[92:95], v[96:99]
    ds_read_b128 v[88:91], v1 offset:14336
    s_waitcnt lgkmcnt(5)
    v_mfma_f32_16x16x32_bf16 v[96:99], a[224:227], v[64:67], v[96:99]
    ds_read_b128 v[92:95], v1 offset:15360
    s_add_u32 m0, s25, 49152
    s_barrier
    v_mfma_f32_16x16x32_bf16 v[96:99], a[228:231], v[68:71], v[96:99]
    ds_read_b128 v[64:67], v1 offset:16384
    s_waitcnt lgkmcnt(5)
    v_mfma_f32_16x16x32_bf16 v[96:99], a[232:235], v[72:75], v[96:99]
    ds_read_b128 v[68:71], v1 offset:17408
    s_add_u32 s91, s72, 49152
    v_mfma_f32_16x16x32_bf16 v[96:99], a[236:239], v[76:79], v[96:99]
    ds_read_b128 v[72:75], v1 offset:18432
    s_waitcnt lgkmcnt(5)
    v_mfma_f32_16x16x32_bf16 v[96:99], a[240:243], v[80:83], v[96:99]
    ds_read_b128 v[76:79], v1 offset:19456
    buffer_load_dwordx4 v1, s[52:55], s91 offen offset:0 sc1 lds
    v_mfma_f32_16x16x32_bf16 v[96:99], a[244:247], v[84:87], v[96:99]
    ds_read_b128 v[80:83], v1 offset:20480
    s_waitcnt lgkmcnt(5)
    v_mfma_f32_16x16x32_bf16 v[96:99], a[248:251], v[88:91], v[96:99]
    ds_read_b128 v[84:87], v1 offset:21504
    v_mfma_f32_16x16x32_bf16 v[96:99], a[252:255], v[92:95], v[96:99]
    ds_read_b128 v[88:91], v1 offset:22528
    s_waitcnt lgkmcnt(5)
    v_mfma_f32_16x16x32_bf16 v[100:103], a[192:195], v[64:67], 0
    ds_read_b128 v[92:95], v1 offset:23552
    v_mfma_f32_16x16x32_bf16 v[100:103], a[196:199], v[68:71], v[100:103]
    ds_read_b128 v[64:67], v1 offset:24576
    s_waitcnt lgkmcnt(5)
    v_mfma_f32_16x16x32_bf16 v[100:103], a[200:203], v[72:75], v[100:103]
    ds_read_b128 v[68:71], v1 offset:25600
    v_mfma_f32_16x16x32_bf16 v[100:103], a[204:207], v[76:79], v[100:103]
    ds_read_b128 v[72:75], v1 offset:26624
    s_waitcnt lgkmcnt(5)
    v_mfma_f32_16x16x32_bf16 v[100:103], a[208:211], v[80:83], v[100:103]
    ds_read_b128 v[76:79], v1 offset:27648
    v_mfma_f32_16x16x32_bf16 v[100:103], a[212:215], v[84:87], v[100:103]
    ds_read_b128 v[80:83], v1 offset:28672
    s_waitcnt lgkmcnt(5)
    v_mfma_f32_16x16x32_bf16 v[100:103], a[216:219], v[88:91], v[100:103]
    ds_read_b128 v[84:87], v1 offset:29696
    v_mfma_f32_16x16x32_bf16 v[100:103], a[220:223], v[92:95], v[100:103]
    ds_read_b128 v[88:91], v1 offset:30720
    s_waitcnt lgkmcnt(5)
    v_mfma_f32_16x16x32_bf16 v[100:103], a[224:227], v[64:67], v[100:103]
    ds_read_b128 v[92:95], v1 offset:31744
    v_mfma_f32_16x16x32_bf16 v[100:103], a[228:231], v[68:71], v[100:103]
    s_waitcnt lgkmcnt(4)
    v_mfma_f32_16x16x32_bf16 v[100:103], a[232:235], v[72:75], v[100:103]
    v_mfma_f32_16x16x32_bf16 v[100:103], a[236:239], v[76:79], v[100:103]
    s_waitcnt lgkmcnt(2)
    v_mfma_f32_16x16x32_bf16 v[100:103], a[240:243], v[80:83], v[100:103]
    v_mfma_f32_16x16x32_bf16 v[100:103], a[244:247], v[84:87], v[100:103]
    s_waitcnt lgkmcnt(0)
    v_mfma_f32_16x16x32_bf16 v[100:103], a[248:251], v[88:91], v[100:103]
    v_mfma_f32_16x16x32_bf16 v[100:103], a[252:255], v[92:95], v[100:103]
    v_pk_fma_f32 v[112:113], v[224:225], v[96:97], v[112:113]
    v_pk_fma_f32 v[114:115], v[226:227], v[98:99], v[114:115]
    v_cvt_pk_bf16_f32 v144, v112, v113
    v_cvt_pk_bf16_f32 v145, v114, v115
    v_lshlrev_b32 v112, 16, v144
    v_and_b32 v113, 0xffff0000, v144
    v_lshlrev_b32 v114, 16, v145
    v_and_b32 v115, 0xffff0000, v145
    v_pk_mul_f32 v[152:153], v[112:113], v[228:229]
    v_pk_mul_f32 v[154:155], v[114:115], v[230:231]
    v_cvt_pk_bf16_f32 v160, v152, v153
    v_cvt_pk_bf16_f32 v161, v154, v155
    v_pk_fma_f32 v[116:117], v[224:225], v[100:101], v[116:117]
    buffer_load_dwordx4 v1, s[52:55], s91 offen offset:1024 sc1 lds
    v_pk_fma_f32 v[118:119], v[226:227], v[102:103], v[118:119]
    v_cvt_pk_bf16_f32 v146, v116, v117
    v_cvt_pk_bf16_f32 v147, v118, v119
    v_lshlrev_b32 v116, 16, v146
    v_and_b32 v117, 0xffff0000, v146
    v_lshlrev_b32 v118, 16, v147
    v_and_b32 v119, 0xffff0000, v147
    v_pk_mul_f32 v[156:157], v[116:117], v[228:229]
    v_pk_mul_f32 v[158:159], v[118:119], v[230:231]
    v_cvt_pk_bf16_f32 v162, v156, v157
    v_cvt_pk_bf16_f32 v163, v158, v159
    s_nop 0
    v_permlane16_swap_b32 v160, v162
    v_permlane16_swap_b32 v161, v163
    buffer_load_dwordx4 v1, s[52:55], s91 offen offset:2048 sc1 lds
    buffer_store_dwordx4 v[160:163], v37, s[52:55], s73 offen sc1
    ds_read_b64_tr_b16 a[36:37], v34 offset:12288
    buffer_load_dwordx4 v1, s[52:55], s91 offen offset:3072 sc1 lds
    ds_read_b64_tr_b16 a[38:39], v34 offset:13824
    s_add_u32 m0, s88, 106496
    s_add_u32 s91, s22, 880640
    buffer_load_dwordx4 v54, s[44:47], s91 offen offset:2048 lds
    ds_read_b64_tr_b16 a[100:101], v35 offset:12288
    s_add_u32 m0, s88, 118784
    s_add_u32 s91, s22, 968704
    buffer_load_dwordx4 v52, s[44:47], s91 offen offset:0 lds
    ds_read_b64_tr_b16 a[102:103], v35 offset:13824
    ds_read_b64_tr_b16 a[164:165], v36 offset:12288
    ds_read_b64_tr_b16 a[166:167], v36 offset:13824
    buffer_load_dwordx4 v53, s[44:47], s91 offen offset:1024 lds
    v_permlane16_swap_b32 v144, v146
    v_permlane16_swap_b32 v145, v147
    v_dot2_f32_bf16 v170, v160, v47, 0
    v_dot2_f32_bf16 v171, v160, v160, 0
    v_dot2_f32_bf16 v172, v160, v232, 0
    v_dot2_f32_bf16 v173, v160, v236, 0
    v_dot2_f32_bf16 v168, v144, v47, 0
    v_dot2_f32_bf16 v169, v144, v144, 0
    v_dot2_f32_bf16 v170, v161, v47, v170
    v_dot2_f32_bf16 v171, v161, v161, v171
    buffer_load_dwordx4 v54, s[44:47], s91 offen offset:2048 lds
    v_dot2_f32_bf16 v172, v161, v233, v172
    v_dot2_f32_bf16 v173, v161, v237, v173
    v_dot2_f32_bf16 v168, v145, v47, v168
    v_dot2_f32_bf16 v169, v145, v145, v169
    v_dot2_f32_bf16 v170, v162, v47, v170
    v_dot2_f32_bf16 v171, v162, v162, v171
    v_dot2_f32_bf16 v172, v162, v234, v172
    v_dot2_f32_bf16 v173, v162, v238, v173
    v_dot2_f32_bf16 v168, v146, v47, v168
    v_dot2_f32_bf16 v169, v146, v146, v169
    v_dot2_f32_bf16 v170, v163, v47, v170
    v_dot2_f32_bf16 v171, v163, v163, v171
    v_dot2_f32_bf16 v172, v163, v235, v172
    v_dot2_f32_bf16 v173, v163, v239, v173
    v_dot2_f32_bf16 v168, v147, v47, v168
    v_dot2_f32_bf16 v169, v147, v147, v169
    s_cmp_lg_u32 s2, 0
    s_cbranch_scc1 Lnoep_25
    s_cmp_lg_u32 s3, 3
    s_cbranch_scc1 Lnoep_25
    s_mov_b32 s69, 4096
Lep_26:
    buffer_load_dwordx4 v[184:187], v1, s[52:55], s69 offen sc1
    buffer_load_dwordx4 v[188:191], v1, s[52:55], s69 offen offset:1024 sc1
    s_waitcnt vmcnt(0)
    v_bitop3_b32 v25, v185, v187, s66 bitop3:0x7e
    v_bitop3_b32 v26, v189, v191, s66 bitop3:0x7e
    v_or_b32 v25, v25, v26
    v_cmp_ne_u32 vcc, 0, v25
    s_nop 0
    s_cbranch_vccz Lepok_27
    s_add_u32 s85, s85, 1
    s_cmp_lt_u32 s85, 400000
    s_cbranch_scc1 Lep_26
Lepok_27:
    v_mov_b32 v26, s66
    v_mov_b32 v27, 0
    s_mov_b64 exec, 1
    buffer_store_dword v26, v27, s[52:55], 0 offen sc1
    s_mov_b64 exec, -1
Lnoep_25:
    s_add_u32 m0, s88, 131072
    s_add_u32 s91, s22, 1056768
    buffer_load_dwordx4 v52, s[44:47], s91 offen offset:0 lds
    s_waitcnt vmcnt(10)
    s_waitcnt lgkmcnt(0)
    s_barrier
    ds_read_b128 v[64:67], v1 offset:32768
    ds_read_b128 v[68:71], v1 offset:33792
    ds_read_b128 v[72:75], v1 offset:34816
    ds_read_b128 v[76:79], v1 offset:35840
    ds_read_b128 v[80:83], v1 offset:36864
    ds_read_b128 v[84:87], v1 offset:37888
    ds_read_b128 v[88:91], v1 offset:38912
    s_waitcnt lgkmcnt(5)
    v_mfma_f32_16x16x32_bf16 v[104:107], a[192:195], v[64:67], 0
    ds_read_b128 v[92:95], v1 offset:39936
    buffer_load_dwordx4 v53, s[44:47], s91 offen offset:1024 lds
    v_mfma_f32_16x16x32_bf16 v[104:107], a[196:199], v[68:71], v[104:107]
    ds_read_b128 v[64:67], v1 offset:40960
    s_waitcnt lgkmcnt(5)
    v_mfma_f32_16x16x32_bf16 v[104:107], a[200:203], v[72:75], v[104:107]
    ds_read_b128 v[68:71], v1 offset:41984
    v_mfma_f32_16x16x32_bf16 v[104:107], a[204:207], v[76:79], v[104:107]
    ds_read_b128 v[72:75], v1 offset:43008
    s_waitcnt lgkmcnt(5)
    v_mfma_f32_16x16x32_bf16 v[104:107], a[208:211], v[80:83], v[104:107]
    ds_read_b128 v[76:79], v1 offset:44032
    v_mfma_f32_16x16x32_bf16 v[104:107], a[212:215], v[84:87], v[104:107]
    ds_read_b128 v[80:83], v1 offset:45056
    s_waitcnt lgkmcnt(5)
    v_mfma_f32_16x16x32_bf16 v[104:107], a[216:219], v[88:91], v[104:107]
    ds_read_b128 v[84:87], v1 offset:46080
    v_mfma_f32_16x16x32_bf16 v[104:107], a[220:223], v[92:95], v[104:107]
    ds_read_b128 v[88:91], v1 offset:47104
    s_waitcnt lgkmcnt(5)
    v_mfma_f32_16x16x32_bf16 v[104:107], a[224:227], v[64:67], v[104:107]
    ds_read_b128 v[92:95], v1 offset:48128
    s_waitcnt vmcnt(6)
    s_barrier
    v_mfma_f32_16x16x32_bf16 v[104:107], a[228:231], v[68:71], v[104:107]
    ds_read_b128 v[64:67], v1 offset:49152
    s_barrier
    s_cmp_lg_u32 s3, 0
    s_cbranch_scc1 Lpub_28
    s_add_u32 s20, s66, 4
    v_mov_b32 v60, s20
    s_mov_b64 exec, 1
    s_cmp_eq_u32 s67, 1
    s_cbranch_scc1 Lpub_29
    buffer_store_dword v60, v41, s[52:55], s17 offen offset:96 sc1
    s_mov_b64 exec, -1
    s_branch Lpub_28
Lpub_29:
    buffer_store_dword v60, v41, s[52:55], s17 offen offset:96
    s_mov_b64 exec, -1
Lpub_28:
    s_waitcnt lgkmcnt(5)
    v_mfma_f32_16x16x32_bf16 v[104:107], a[232:235], v[72:75], v[104:107]
    ds_read_b128 v[68:71], v1 offset:50176
    buffer_load_dwordx4 v54, s[44:47], s91 offen offset:2048 lds
    v_mfma_f32_16x16x32_bf16 v[104:107], a[236:239], v[76:79], v[104:107]
    ds_read_b128 v[72:75], v1 offset:51200
    s_waitcnt lgkmcnt(5)
    v_mfma_f32_16x16x32_bf16 v[104:107], a[240:243], v[80:83], v[104:107]
    ds_read_b128 v[76:79], v1 offset:52224
    global_load_dword v5, v61, s[0:1]
    v_mfma_f32_16x16x32_bf16 v[104:107], a[244:247], v[84:87], v[104:107]
    ds_read_b128 v[80:83], v1 offset:53248
    s_waitcnt lgkmcnt(5)
    v_mfma_f32_16x16x32_bf16 v[104:107], a[248:251], v[88:91], v[104:107]
    ds_read_b128 v[84:87], v1 offset:54272
    s_add_u32 m0, s88, 65536
    v_mfma_f32_16x16x32_bf16 v[104:107], a[252:255], v[92:95], v[104:107]
    ds_read_b128 v[88:91], v1 offset:55296
    s_waitcnt lgkmcnt(5)
    v_mfma_f32_16x16x32_bf16 v[108:111], a[192:195], v[64:67], 0
    ds_read_b128 v[92:95], v1 offset:56320
    s_add_u32 s91, s22, 1144832
    v_mfma_f32_16x16x32_bf16 v[108:111], a[196:199], v[68:71], v[108:111]
    ds_read_b128 v[64:67], v1 offset:57344
    s_waitcnt lgkmcnt(5)
    v_mfma_f32_16x16x32_bf16 v[108:111], a[200:203], v[72:75], v[108:111]
    ds_read_b128 v[68:71], v1 offset:58368
    buffer_load_dwordx4 v52, s[44:47], s91 offen offset:0 lds
    v_mfma_f32_16x16x32_bf16 v[108:111], a[204:207], v[76:79], v[108:111]
    ds_read_b128 v[72:75], v1 offset:59392
    s_waitcnt lgkmcnt(5)
    v_mfma_f32_16x16x32_bf16 v[108:111], a[208:211], v[80:83], v[108:111]
    ds_read_b128 v[76:79], v1 offset:60416
    buffer_load_dwordx4 v53, s[44:47], s91 offen offset:1024 lds
    v_mfma_f32_16x16x32_bf16 v[108:111], a[212:215], v[84:87], v[108:111]
    ds_read_b128 v[80:83], v1 offset:61440
    s_waitcnt lgkmcnt(5)
    v_mfma_f32_16x16x32_bf16 v[108:111], a[216:219], v[88:91], v[108:111]
    ds_read_b128 v[84:87], v1 offset:62464
    buffer_load_dwordx4 v54, s[44:47], s91 offen offset:2048 lds
    v_mfma_f32_16x16x32_bf16 v[108:111], a[220:223], v[92:95], v[108:111]
    ds_read_b128 v[88:91], v1 offset:63488
    s_waitcnt lgkmcnt(5)
    v_mfma_f32_16x16x32_bf16 v[108:111], a[224:227], v[64:67], v[108:111]
    ds_read_b128 v[92:95], v1 offset:64512
    s_add_u32 m0, s88, 81920
    v_mfma_f32_16x16x32_bf16 v[108:111], a[228:231], v[68:71], v[108:111]
    s_add_u32 s91, s22, 1232896
    s_waitcnt lgkmcnt(4)
    v_mfma_f32_16x16x32_bf16 v[108:111], a[232:235], v[72:75], v[108:111]
    buffer_load_dwordx4 v52, s[44:47], s91 offen offset:0 lds
    v_mfma_f32_16x16x32_bf16 v[108:111], a[236:239], v[76:79], v[108:111]
    s_waitcnt lgkmcnt(2)
    v_mfma_f32_16x16x32_bf16 v[108:111], a[240:243], v[80:83], v[108:111]
    buffer_load_dwordx4 v53, s[44:47], s91 offen offset:1024 lds
    buffer_load_dword v40, v39, s[52:55], s17 offen offset:96 sc1
    v_mfma_f32_16x16x32_bf16 v[108:111], a[244:247], v[84:87], v[108:111]
    s_add_u32 m0, s88, 81920
    s_waitcnt lgkmcnt(0)
    v_mfma_f32_16x16x32_bf16 v[108:111], a[248:251], v[88:91], v[108:111]
    s_add_u32 s91, s22, 1232896
    v_mfma_f32_16x16x32_bf16 v[108:111], a[252:255], v[92:95], v[108:111]
    v_pk_fma_f32 v[120:121], v[224:225], v[104:105], v[120:121]
    v_pk_fma_f32 v[122:123], v[226:227], v[106:107], v[122:123]
    v_cvt_pk_bf16_f32 v148, v120, v121
    v_cvt_pk_bf16_f32 v149, v122, v123
    v_lshlrev_b32 v120, 16, v148
    v_and_b32 v121, 0xffff0000, v148
    v_lshlrev_b32 v122, 16, v149
    v_and_b32 v123, 0xffff0000, v149
    v_pk_mul_f32 v[152:153], v[120:121], v[228:229]
    v_pk_mul_f32 v[154:155], v[122:123], v[230:231]
    v_cvt_pk_bf16_f32 v164, v152, v153
    v_cvt_pk_bf16_f32 v165, v154, v155
    v_pk_fma_f32 v[124:125], v[224:225], v[108:109], v[124:125]
    v_pk_fma_f32 v[126:127], v[226:227], v[110:111], v[126:127]
    v_cvt_pk_bf16_f32 v150, v124, v125
    v_cvt_pk_bf16_f32 v151, v126, v127
    v_lshlrev_b32 v124, 16, v150
    v_and_b32 v125, 0xffff0000, v150
    v_lshlrev_b32 v126, 16, v151
    v_and_b32 v127, 0xffff0000, v151
    v_pk_mul_f32 v[156:157], v[124:125], v[228:229]
    v_pk_mul_f32 v[158:159], v[126:127], v[230:231]
    v_cvt_pk_bf16_f32 v166, v156, v157
    v_cvt_pk_bf16_f32 v167, v158, v159
    s_nop 0
    v_permlane16_swap_b32 v164, v166
    v_permlane16_swap_b32 v165, v167
    buffer_store_dwordx4 v[164:167], v37, s[52:55], s75 offen sc1
    s_waitcnt vmcnt(11)
    s_barrier
    ds_read_b64_tr_b16 a[40:41], v34 offset:24576
    buffer_load_dwordx4 v54, s[44:47], s91 offen offset:2048 lds
    ds_read_b64_tr_b16 a[42:43], v34 offset:26112
    ds_read_b64_tr_b16 a[104:105], v35 offset:24576
    ds_read_b64_tr_b16 a[106:107], v35 offset:26112
    ds_read_b64_tr_b16 a[168:169], v36 offset:24576
    ds_read_b64_tr_b16 a[170:171], v36 offset:26112
    ds_read_b64_tr_b16 a[44:45], v34 offset:36864
    ds_read_b64_tr_b16 a[46:47], v34 offset:38400
    ds_read_b64_tr_b16 a[108:109], v35 offset:36864
    ds_read_b64_tr_b16 a[110:111], v35 offset:38400
    ds_read_b64_tr_b16 a[172:173], v36 offset:36864
    s_add_u32 m0, s88, 94208
    s_add_u32 s91, s22, 1320960
    buffer_load_dwordx4 v52, s[44:47], s91 offen offset:0 lds
    ds_read_b64_tr_b16 a[174:175], v36 offset:38400
    v_permlane16_swap_b32 v148, v150
    v_permlane16_swap_b32 v149, v151
    v_dot2_f32_bf16 v178, v164, v47, 0
    buffer_load_dwordx4 v53, s[44:47], s91 offen offset:1024 lds
    v_dot2_f32_bf16 v179, v164, v164, 0
    v_dot2_f32_bf16 v180, v164, v232, 0
    v_dot2_f32_bf16 v181, v164, v236, 0
    v_dot2_f32_bf16 v176, v148, v47, 0
    v_dot2_f32_bf16 v177, v148, v148, 0
    v_dot2_f32_bf16 v178, v165, v47, v178
    v_dot2_f32_bf16 v179, v165, v165, v179
    v_dot2_f32_bf16 v180, v165, v233, v180
    v_dot2_f32_bf16 v181, v165, v237, v181
    v_dot2_f32_bf16 v176, v149, v47, v176
    v_dot2_f32_bf16 v177, v149, v149, v177
    buffer_load_dwordx4 v54, s[44:47], s91 offen offset:2048 lds
    v_dot2_f32_bf16 v178, v166, v47, v178
    v_dot2_f32_bf16 v179, v166, v166, v179
    v_dot2_f32_bf16 v180, v166, v234, v180
    v_dot2_f32_bf16 v181, v166, v238, v181
    v_dot2_f32_bf16 v176, v150, v47, v176
    v_dot2_f32_bf16 v177, v150, v150, v177
    v_dot2_f32_bf16 v178, v167, v47, v178
    v_dot2_f32_bf16 v179, v167, v167, v179
    v_dot2_f32_bf16 v180, v167, v235, v180
    v_dot2_f32_bf16 v181, v167, v239, v181
    v_dot2_f32_bf16 v176, v151, v47, v176
    v_dot2_f32_bf16 v177, v151, v151, v177
    s_nop 1
    v_permlane32_swap_b32 v168, v176
    v_permlane32_swap_b32 v169, v177
    v_permlane32_swap_b32 v170, v178
    v_permlane32_swap_b32 v171, v179
    v_permlane32_swap_b32 v172, v180
    v_permlane32_swap_b32 v173, v181
    v_add_f32 v168, v168, v176
    v_add_f32 v169, v169, v177
    v_add_f32 v170, v170, v178
    v_add_f32 v171, v171, v179
    v_add_f32 v172, v172, v180
    v_add_f32 v173, v173, v181
    ds_write_b64 v29, v[168:169] offset:0
    ds_write_b64 v29, v[170:171] offset:512
    ds_write_b64 v29, v[172:173] offset:1024
    s_waitcnt lgkmcnt(0)
    s_waitcnt vmcnt(8)
    s_barrier
    ds_read_b64 v[248:249], v30 offset:0
    s_add_u32 s20, s66, 4
    s_waitcnt vmcnt(5)
    v_cmp_ne_u32 s[28:29], s20, v40
    s_nop 0
    s_cmp_eq_u64 s[28:29], 0
    s_cbranch_scc1 Lwok_31
Lw_30:
    buffer_load_dword v40, v39, s[52:55], s17 offen offset:96 sc1
    s_waitcnt vmcnt(0)
    v_cmp_ne_u32 s[28:29], s20, v40
    s_nop 0
    s_cmp_eq_u64 s[28:29], 0
    s_cbranch_scc1 Lwok_31
    s_add_u32 s85, s85, 1
    s_cmp_lt_u32 s85, 400000
    s_cbranch_scc1 Lw_30
Lwok_31:
    s_add_u32 s72, s72, 176128
    s_add_u32 m0, s25, 114688
    s_add_u32 s91, s89, 0
    buffer_load_dwordx4 v6, s[48:51], s91 offen offset:0 lds
    s_add_u32 m0, s25, 0
    s_add_u32 s91, s72, 0
    buffer_load_dwordx4 v1, s[52:55], s91 offen offset:0 sc1 lds
    buffer_load_dwordx4 v1, s[52:55], s91 offen offset:1024 sc1 lds
    buffer_load_dwordx4 v1, s[52:55], s91 offen offset:2048 sc1 lds
    ds_read_b64 v[250:251], v30 offset:1536
    ds_read_b64 v[252:253], v30 offset:3072
    ds_read_b64 v[254:255], v30 offset:4608
    ds_read_b64_tr_b16 a[48:49], v34 offset:49152
    ds_read_b64_tr_b16 a[50:51], v34 offset:50688
    ds_read_b64_tr_b16 a[112:113], v35 offset:49152
    ds_read_b64_tr_b16 a[114:115], v35 offset:50688
    ds_read_b64_tr_b16 a[176:177], v36 offset:49152
    ds_read_b64_tr_b16 a[178:179], v36 offset:50688
    ds_read_b64_tr_b16 a[52:53], v10 offset:57344
    ds_read_b64_tr_b16 a[54:55], v10 offset:58880
    ds_read_b64_tr_b16 a[116:117], v11 offset:57344
    ds_read_b64_tr_b16 a[118:119], v11 offset:58880
    ds_read_b64_tr_b16 a[180:181], v12 offset:57344
    ds_read_b64_tr_b16 a[182:183], v12 offset:58880
    s_waitcnt lgkmcnt(12)
    v_pk_add_f32 v[248:249], v[248:249], v[250:251]
    v_pk_add_f32 v[252:253], v[252:253], v[254:255]
    v_mov_b32 v251, s66
    v_add_f32 v250, v249, v253
    v_add_f32 v248, v248, v252
    v_mov_b32 v249, s66
    buffer_store_dwordx4 v[248:251], v1, s[52:55], s79 offen sc1
    ds_read_b128 v[184:187], v44 offset:448
    ds_read_b128 v[188:191], v44 offset:512
    s_waitcnt lgkmcnt(1)
    v_mfma_f32_16x16x32_bf16 v[128:131], v[184:187], a[28:31], v[128:131]
    buffer_load_dwordx4 v1, s[52:55], s91 offen offset:3072 sc1 lds
    s_add_u32 m0, s25, 16384
    v_mfma_f32_16x16x32_bf16 v[132:135], v[184:187], a[92:95], v[132:135]
    s_add_u32 s91, s72, 16384
    v_mfma_f32_16x16x32_bf16 v[136:139], v[184:187], a[156:159], v[136:139]
    buffer_load_dwordx4 v1, s[52:55], s91 offen offset:0 sc1 lds
    s_waitcnt lgkmcnt(0)
    v_mfma_f32_16x16x32_bf16 v[128:131], v[188:191], a[32:35], v[128:131]
    v_mfma_f32_16x16x32_bf16 v[132:135], v[188:191], a[96:99], v[132:135]
    buffer_load_dwordx4 v1, s[52:55], s91 offen offset:1024 sc1 lds
    v_mfma_f32_16x16x32_bf16 v[136:139], v[188:191], a[160:163], v[136:139]
    s_waitcnt vmcnt(12)
    s_barrier
    s_cmp_lg_u32 s3, 0
    s_cbranch_scc1 Lpub_32
    s_add_u32 s20, s66, 5
    v_mov_b32 v60, s20
    s_mov_b64 exec, 1
    s_cmp_eq_u32 s67, 1
    s_cbranch_scc1 Lpub_33
    buffer_store_dword v60, v41, s[52:55], s17 offen offset:128 sc1
    s_mov_b64 exec, -1
    s_branch Lpub_32
Lpub_33:
    buffer_store_dword v60, v41, s[52:55], s17 offen offset:128
    s_mov_b64 exec, -1
Lpub_32:
    ds_read_b128 v[184:187], v44 offset:576
    ds_read_b128 v[188:191], v44 offset:640
    s_waitcnt lgkmcnt(1)
    v_mfma_f32_16x16x32_bf16 v[128:131], v[184:187], a[36:39], v[128:131]
    buffer_load_dwordx4 v1, s[52:55], s91 offen offset:2048 sc1 lds
    v_mfma_f32_16x16x32_bf16 v[132:135], v[184:187], a[100:103], v[132:135]
    buffer_load_dwordx4 v1, s[52:55], s91 offen offset:3072 sc1 lds
    s_add_u32 m0, s25, 114688
    v_mfma_f32_16x16x32_bf16 v[136:139], v[184:187], a[164:167], v[136:139]
    s_add_u32 s91, s89, 0
    s_waitcnt lgkmcnt(0)
    v_mfma_f32_16x16x32_bf16 v[128:131], v[188:191], a[40:43], v[128:131]
    v_mfma_f32_16x16x32_bf16 v[132:135], v[188:191], a[104:107], v[132:135]
    v_mfma_f32_16x16x32_bf16 v[136:139], v[188:191], a[168:171], v[136:139]
    s_waitcnt vmcnt(10)
    s_barrier
    ds_read_b64_tr_b16 a[56:57], v34 offset:0
    ds_read_b64_tr_b16 a[58:59], v34 offset:1536
    ds_read_b64_tr_b16 a[120:121], v35 offset:0
    ds_read_b64_tr_b16 a[122:123], v35 offset:1536
    ds_read_b64_tr_b16 a[184:185], v36 offset:0
    ds_read_b64_tr_b16 a[186:187], v36 offset:1536
    ds_read_b64_tr_b16 a[60:61], v34 offset:12288
    ds_read_b64_tr_b16 a[62:63], v34 offset:13824
    ds_read_b64_tr_b16 a[124:125], v35 offset:12288
    ds_read_b64_tr_b16 a[126:127], v35 offset:13824
    ds_read_b64_tr_b16 a[188:189], v36 offset:12288
    ds_read_b64_tr_b16 a[190:191], v36 offset:13824
    ds_read_b128 v[184:187], v44 offset:704
    ds_read_b128 v[188:191], v44 offset:768
    s_waitcnt lgkmcnt(1)
    v_mfma_f32_16x16x32_bf16 v[128:131], v[184:187], a[44:47], v[128:131]
    v_mfma_f32_16x16x32_bf16 v[132:135], v[184:187], a[108:111], v[132:135]
    v_mfma_f32_16x16x32_bf16 v[136:139], v[184:187], a[172:175], v[136:139]
    s_waitcnt lgkmcnt(0)
    v_mfma_f32_16x16x32_bf16 v[128:131], v[188:191], a[48:51], v[128:131]
    v_mfma_f32_16x16x32_bf16 v[132:135], v[188:191], a[112:115], v[132:135]
    v_mfma_f32_16x16x32_bf16 v[136:139], v[188:191], a[176:179], v[136:139]
    ds_read_b128 v[184:187], v44 offset:832
    ds_read_b128 v[188:191], v44 offset:896
    s_waitcnt lgkmcnt(1)
    v_mfma_f32_16x16x32_bf16 v[128:131], v[184:187], a[52:55], v[128:131]
    v_mfma_f32_16x16x32_bf16 v[132:135], v[184:187], a[116:119], v[132:135]
    v_mfma_f32_16x16x32_bf16 v[136:139], v[184:187], a[180:183], v[136:139]
    s_waitcnt lgkmcnt(0)
    v_mfma_f32_16x16x32_bf16 v[128:131], v[188:191], a[56:59], v[128:131]
    v_mfma_f32_16x16x32_bf16 v[132:135], v[188:191], a[120:123], v[132:135]
    v_mfma_f32_16x16x32_bf16 v[136:139], v[188:191], a[184:187], v[136:139]
    ds_read_b128 v[184:187], v44 offset:960
    s_waitcnt lgkmcnt(0)
    v_mfma_f32_16x16x32_bf16 v[128:131], v[184:187], a[60:63], v[128:131]
    v_mfma_f32_16x16x32_bf16 v[132:135], v[184:187], a[124:127], v[132:135]
    v_mfma_f32_16x16x32_bf16 v[136:139], v[184:187], a[188:191], v[136:139]
    s_waitcnt vmcnt(0)
    s_barrier
    ds_read_b128 v[64:67], v1 offset:0
    ds_read_b128 v[68:71], v1 offset:16384
    ds_read_b128 v[72:75], v1 offset:1024
    ds_read_b128 v[76:79], v1 offset:17408
    ds_read_b128 v[80:83], v1 offset:2048
    ds_read_b128 v[84:87], v1 offset:18432
    ds_read_b128 v[88:91], v1 offset:3072
    buffer_load_dword v40, v39, s[52:55], s17 offen offset:128 sc1
    s_waitcnt lgkmcnt(5)
    v_mfma_f32_16x16x32_bf16 v[168:171], a[0:3], v[64:67], 0
    ds_read_b128 v[92:95], v1 offset:19456
    s_add_u32 m0, s25, 114688
    v_mfma_f32_16x16x32_bf16 v[172:175], a[64:67], v[64:67], 0
    s_add_u32 s91, s89, 0
    s_add_u32 s77, s98, 88064
    v_mfma_f32_16x16x32_bf16 v[176:179], a[128:131], v[64:67], 0
    s_mul_i32 s4, s3, 11264
    s_add_u32 s4, s4, s86
    v_mfma_f32_16x16x32_bf16 v[180:183], a[0:3], v[68:71], 0
    ds_read_b128 v[64:67], v1 offset:4096
    s_add_u32 s5, s4, 4096
    v_mfma_f32_16x16x32_bf16 v[184:187], a[64:67], v[68:71], 0
    s_add_u32 s6, s4, 8192
    s_add_u32 s7, s4, 44032
    v_mfma_f32_16x16x32_bf16 v[188:191], a[128:131], v[68:71], 0
    s_add_u32 s8, s4, 48128
    s_waitcnt lgkmcnt(5)
    v_mfma_f32_16x16x32_bf16 v[168:171], a[4:7], v[72:75], v[168:171]
    ds_read_b128 v[68:71], v1 offset:20480
    s_add_u32 s9, s4, 52224
    v_mfma_f32_16x16x32_bf16 v[172:175], a[68:71], v[72:75], v[172:175]
    s_add_u32 s10, s4, 88064
    s_add_u32 s11, s4, 92160
    v_mfma_f32_16x16x32_bf16 v[176:179], a[132:135], v[72:75], v[176:179]
    s_add_u32 s12, s4, 96256
    s_add_u32 s13, s4, 132096
    v_mfma_f32_16x16x32_bf16 v[180:183], a[4:7], v[76:79], v[180:183]
    ds_read_b128 v[72:75], v1 offset:5120
    v_lshlrev_b32 v55, 16, v55
    v_mfma_f32_16x16x32_bf16 v[184:187], a[68:71], v[76:79], v[184:187]
    buffer_load_dwordx4 v[144:147], v45, s[52:55], s97 offen offset:0 sc1
    v_lshlrev_b32 v56, 16, v56
    v_mfma_f32_16x16x32_bf16 v[188:191], a[132:135], v[76:79], v[188:191]
    buffer_load_dwordx4 v[148:151], v45, s[52:55], s97 offen offset:1024 sc1
    s_waitcnt lgkmcnt(5)
    v_mfma_f32_16x16x32_bf16 v[168:171], a[8:11], v[80:83], v[168:171]
    ds_read_b128 v[76:79], v1 offset:21504
    v_lshlrev_b32 v57, 16, v57
    v_mfma_f32_16x16x32_bf16 v[172:175], a[72:75], v[80:83], v[172:175]
    buffer_load_dwordx4 v[152:155], v45, s[52:55], s97 offen offset:2048 sc1
    v_mfma_f32_16x16x32_bf16 v[176:179], a[136:139], v[80:83], v[176:179]
    buffer_load_dwordx4 v[156:159], v45, s[52:55], s76 offen offset:0 sc1
    v_mfma_f32_16x16x32_bf16 v[180:183], a[8:11], v[84:87], v[180:183]
    ds_read_b128 v[80:83], v1 offset:6144
    v_mfma_f32_16x16x32_bf16 v[184:187], a[72:75], v[84:87], v[184:187]
    buffer_load_dwordx4 v[160:163], v45, s[52:55], s76 offen offset:1024 sc1
    v_mfma_f32_16x16x32_bf16 v[188:191], a[136:139], v[84:87], v[188:191]
    s_waitcnt lgkmcnt(5)
    v_mfma_f32_16x16x32_bf16 v[168:171], a[12:15], v[88:91], v[168:171]
    ds_read_b128 v[84:87], v1 offset:22528
    v_mfma_f32_16x16x32_bf16 v[172:175], a[76:79], v[88:91], v[172:175]
    buffer_load_dwordx4 v[164:167], v45, s[52:55], s76 offen offset:2048 sc1
    s_add_u32 m0, s25, 114688
    v_mfma_f32_16x16x32_bf16 v[176:179], a[140:143], v[88:91], v[176:179]
    s_add_u32 s91, s89, 0
    v_mfma_f32_16x16x32_bf16 v[180:183], a[12:15], v[92:95], v[180:183]
    ds_read_b128 v[88:91], v1 offset:7168
    v_mfma_f32_16x16x32_bf16 v[184:187], a[76:79], v[92:95], v[184:187]
    v_mfma_f32_16x16x32_bf16 v[188:191], a[140:143], v[92:95], v[188:191]
    s_waitcnt lgkmcnt(5)
    v_mfma_f32_16x16x32_bf16 v[168:171], a[16:19], v[64:67], v[168:171]
    ds_read_b128 v[92:95], v1 offset:23552
    v_mfma_f32_16x16x32_bf16 v[172:175], a[80:83], v[64:67], v[172:175]
    v_mfma_f32_16x16x32_bf16 v[176:179], a[144:147], v[64:67], v[176:179]
    s_add_u32 s20, s66, 5
    s_waitcnt vmcnt(6)
    v_cmp_ne_u32 s[28:29], s20, v40
    s_nop 0
    s_cmp_eq_u64 s[28:29], 0
    s_cbranch_scc1 Lwok_35
Lw_34:
    buffer_load_dword v40, v39, s[52:55], s17 offen offset:128 sc1
    s_waitcnt vmcnt(0)
    v_cmp_ne_u32 s[28:29], s20, v40
    s_nop 0
    s_cmp_eq_u64 s[28:29], 0
    s_cbranch_scc1 Lwok_35
    s_add_u32 s85, s85, 1
    s_cmp_lt_u32 s85, 400000
    s_cbranch_scc1 Lw_34
Lwok_35:
    s_add_u32 m0, s25, 32768
    s_add_u32 s91, s72, 32768
    buffer_load_dwordx4 v1, s[52:55], s91 offen offset:0 sc1 lds
    buffer_load_dwordx4 v1, s[52:55], s91 offen offset:1024 sc1 lds
    v_mfma_f32_16x16x32_bf16 v[180:183], a[16:19], v[68:71], v[180:183]
    ds_read_b128 v[64:67], v1 offset:8192
    v_mfma_f32_16x16x32_bf16 v[184:187], a[80:83], v[68:71], v[184:187]
    v_mfma_f32_16x16x32_bf16 v[188:191], a[144:147], v[68:71], v[188:191]
    s_waitcnt lgkmcnt(5)
    v_mfma_f32_16x16x32_bf16 v[168:171], a[20:23], v[72:75], v[168:171]
    ds_read_b128 v[68:71], v1 offset:24576
    v_mfma_f32_16x16x32_bf16 v[172:175], a[84:87], v[72:75], v[172:175]
    v_mfma_f32_16x16x32_bf16 v[176:179], a[148:151], v[72:75], v[176:179]
    v_mfma_f32_16x16x32_bf16 v[180:183], a[20:23], v[76:79], v[180:183]
    ds_read_b128 v[72:75], v1 offset:9216
    v_mfma_f32_16x16x32_bf16 v[184:187], a[84:87], v[76:79], v[184:187]
    v_mfma_f32_16x16x32_bf16 v[188:191], a[148:151], v[76:79], v[188:191]
    buffer_load_dwordx4 v1, s[52:55], s91 offen offset:2048 sc1 lds
    s_waitcnt lgkmcnt(5)
    v_mfma_f32_16x16x32_bf16 v[168:171], a[24:27], v[80:83], v[168:171]
    ds_read_b128 v[76:79], v1 offset:25600
    v_mfma_f32_16x16x32_bf16 v[172:175], a[88:91], v[80:83], v[172:175]
    v_mfma_f32_16x16x32_bf16 v[176:179], a[152:155], v[80:83], v[176:179]
    v_mfma_f32_16x16x32_bf16 v[180:183], a[24:27], v[84:87], v[180:183]
    ds_read_b128 v[80:83], v1 offset:10240
    v_mfma_f32_16x16x32_bf16 v[184:187], a[88:91], v[84:87], v[184:187]
    buffer_load_dwordx4 v1, s[52:55], s91 offen offset:3072 sc1 lds
    s_add_u32 m0, s25, 49152
    v_mfma_f32_16x16x32_bf16 v[188:191], a[152:155], v[84:87], v[188:191]
    s_add_u32 s91, s72, 49152
    s_waitcnt lgkmcnt(5)
    v_mfma_f32_16x16x32_bf16 v[168:171], a[28:31], v[88:91], v[168:171]
    ds_read_b128 v[84:87], v1 offset:26624
    v_mfma_f32_16x16x32_bf16 v[172:175], a[92:95], v[88:91], v[172:175]
    buffer_load_dwordx4 v1, s[52:55], s91 offen offset:0 sc1 lds
    v_mfma_f32_16x16x32_bf16 v[176:179], a[156:159], v[88:91], v[176:179]
    v_mfma_f32_16x16x32_bf16 v[180:183], a[28:31], v[92:95], v[180:183]
    ds_read_b128 v[88:91], v1 offset:11264
    v_mfma_f32_16x16x32_bf16 v[184:187], a[92:95], v[92:95], v[184:187]
    v_mfma_f32_16x16x32_bf16 v[188:191], a[156:159], v[92:95], v[188:191]
    buffer_load_dwordx4 v1, s[52:55], s91 offen offset:1024 sc1 lds
    s_waitcnt lgkmcnt(5)
    v_mfma_f32_16x16x32_bf16 v[168:171], a[32:35], v[64:67], v[168:171]
    ds_read_b128 v[92:95], v1 offset:27648
    v_mfma_f32_16x16x32_bf16 v[172:175], a[96:99], v[64:67], v[172:175]
    v_mfma_f32_16x16x32_bf16 v[176:179], a[160:163], v[64:67], v[176:179]
    v_mfma_f32_16x16x32_bf16 v[180:183], a[32:35], v[68:71], v[180:183]
    ds_read_b128 v[64:67], v1 offset:12288
    v_mfma_f32_16x16x32_bf16 v[184:187], a[96:99], v[68:71], v[184:187]
    buffer_load_dwordx4 v1, s[52:55], s91 offen offset:2048 sc1 lds
    v_mfma_f32_16x16x32_bf16 v[188:191], a[160:163], v[68:71], v[188:191]
    s_waitcnt lgkmcnt(5)
    v_mfma_f32_16x16x32_bf16 v[168:171], a[36:39], v[72:75], v[168:171]
    ds_read_b128 v[68:71], v1 offset:28672
    v_mfma_f32_16x16x32_bf16 v[172:175], a[100:103], v[72:75], v[172:175]
    buffer_load_dwordx4 v1, s[52:55], s91 offen offset:3072 sc1 lds
    s_add_u32 m0, s25, 114688
    v_mfma_f32_16x16x32_bf16 v[176:179], a[164:167], v[72:75], v[176:179]
    s_add_u32 s91, s89, 0
    v_mfma_f32_16x16x32_bf16 v[180:183], a[36:39], v[76:79], v[180:183]
    ds_read_b128 v[72:75], v1 offset:13312
    v_mfma_f32_16x16x32_bf16 v[184:187], a[100:103], v[76:79], v[184:187]
    v_mfma_f32_16x16x32_bf16 v[188:191], a[164:167], v[76:79], v[188:191]
    buffer_load_dwordx4 v7, s[48:51], s91 offen offset:1024 lds
    s_waitcnt lgkmcnt(5)
    v_mfma_f32_16x16x32_bf16 v[168:171], a[40:43], v[80:83], v[168:171]
    ds_read_b128 v[76:79], v1 offset:29696
    v_mfma_f32_16x16x32_bf16 v[172:175], a[104:107], v[80:83], v[172:175]
    v_mfma_f32_16x16x32_bf16 v[176:179], a[168:171], v[80:83], v[176:179]
    v_mfma_f32_16x16x32_bf16 v[180:183], a[40:43], v[84:87], v[180:183]
    ds_read_b128 v[80:83], v1 offset:14336
    v_mfma_f32_16x16x32_bf16 v[184:187], a[104:107], v[84:87], v[184:187]
    buffer_load_dwordx4 v8, s[48:51], s91 offen offset:2048 lds
    v_mfma_f32_16x16x32_bf16 v[188:191], a[168:171], v[84:87], v[188:191]
    s_waitcnt lgkmcnt(5)
    v_mfma_f32_16x16x32_bf16 v[168:171], a[44:47], v[88:91], v[168:171]
    ds_read_b128 v[84:87], v1 offset:30720
    v_mfma_f32_16x16x32_bf16 v[172:175], a[108:111], v[88:91], v[172:175]
    v_mfma_f32_16x16x32_bf16 v[176:179], a[172:175], v[88:91], v[176:179]
    v_mfma_f32_16x16x32_bf16 v[180:183], a[44:47], v[92:95], v[180:183]
    ds_read_b128 v[88:91], v1 offset:15360
    v_mfma_f32_16x16x32_bf16 v[184:187], a[108:111], v[92:95], v[184:187]
    v_mfma_f32_16x16x32_bf16 v[188:191], a[172:175], v[92:95], v[188:191]
    s_waitcnt vmcnt(10)
    v_bitop3_b32 v25, v145, v147, s66 bitop3:0x7e
    v_bitop3_b32 v26, v149, v151, s66 bitop3:0x7e
    v_or_b32 v25, v25, v26
    v_bitop3_b32 v26, v153, v155, s66 bitop3:0x7e
    v_or_b32 v25, v25, v26
    v_bitop3_b32 v26, v157, v159, s66 bitop3:0x7e
    v_or_b32 v25, v25, v26
    v_bitop3_b32 v26, v161, v163, s66 bitop3:0x7e
    v_or_b32 v25, v25, v26
    v_bitop3_b32 v26, v165, v167, s66 bitop3:0x7e
    v_or_b32 v25, v25, v26
    v_cmp_ne_u32 vcc, 0, v25
    s_nop 0
    s_cbranch_vccz Lgok_37
Lg_36:
    buffer_load_dwordx4 v[144:147], v45, s[52:55], s97 offen offset:0 sc1
    buffer_load_dwordx4 v[148:151], v45, s[52:55], s97 offen offset:1024 sc1
    buffer_load_dwordx4 v[152:155], v45, s[52:55], s97 offen offset:2048 sc1
    buffer_load_dwordx4 v[156:159], v45, s[52:55], s76 offen offset:0 sc1
    buffer_load_dwordx4 v[160:163], v45, s[52:55], s76 offen offset:1024 sc1
    buffer_load_dwordx4 v[164:167], v45, s[52:55], s76 offen offset:2048 sc1
    s_waitcnt vmcnt(0)
    v_bitop3_b32 v25, v145, v147, s66 bitop3:0x7e
    v_bitop3_b32 v26, v149, v151, s66 bitop3:0x7e
    v_or_b32 v25, v25, v26
    v_bitop3_b32 v26, v153, v155, s66 bitop3:0x7e
    v_or_b32 v25, v25, v26
    v_bitop3_b32 v26, v157, v159, s66 bitop3:0x7e
    v_or_b32 v25, v25, v26
    v_bitop3_b32 v26, v161, v163, s66 bitop3:0x7e
    v_or_b32 v25, v25, v26
    v_bitop3_b32 v26, v165, v167, s66 bitop3:0x7e
    v_or_b32 v25, v25, v26
    v_cmp_ne_u32 vcc, 0, v25
    s_nop 0
    s_cbranch_vccz Lgok_37
    s_add_u32 s85, s85, 1
    s_cmp_lt_u32 s85, 400000
    s_cbranch_scc1 Lg_36
Lgok_37:
    s_waitcnt lgkmcnt(5)
    v_mfma_f32_16x16x32_bf16 v[168:171], a[48:51], v[64:67], v[168:171]
    ds_read_b128 v[92:95], v1 offset:31744
    v_add_f32 v144, v144, v156
    v_add_f32 v146, v146, v158
    v_add_f32 v148, v148, v160
    v_mfma_f32_16x16x32_bf16 v[172:175], a[112:115], v[64:67], v[172:175]
    buffer_load_dwordx4 v9, s[48:51], s91 offen offset:3072 lds
    s_add_u32 m0, s25, 65536
    s_add_u32 s91, s89, 32768
    v_add_f32 v150, v150, v162
    v_mfma_f32_16x16x32_bf16 v[176:179], a[176:179], v[64:67], v[176:179]
    buffer_load_dwordx4 v6, s[48:51], s91 offen offset:0 lds
    v_add_f32 v152, v152, v164
    v_add_f32 v154, v154, v166
    v_mov_b32 v145, v144
    v_mfma_f32_16x16x32_bf16 v[180:183], a[48:51], v[68:71], v[180:183]
    v_mov_b32 v147, v146
    v_mov_b32 v149, v148
    v_mov_b32 v151, v150
    v_mov_b32 v153, v152
    v_mfma_f32_16x16x32_bf16 v[184:187], a[112:115], v[68:71], v[184:187]
    buffer_load_dwordx4 v7, s[48:51], s91 offen offset:1024 lds
    v_mov_b32 v155, v154
    v_permlane16_swap_b32 v144, v145
    v_mfma_f32_16x16x32_bf16 v[188:191], a[176:179], v[68:71], v[188:191]
    v_permlane16_swap_b32 v146, v147
    v_permlane16_swap_b32 v148, v149
    v_permlane16_swap_b32 v150, v151
    v_permlane16_swap_b32 v152, v153
    v_permlane16_swap_b32 v154, v155
    buffer_load_dwordx4 v8, s[48:51], s91 offen offset:2048 lds
    v_add_f32 v144, v144, v145
    v_add_f32 v146, v146, v147
    v_add_f32 v148, v148, v149
    v_add_f32 v150, v150, v151
    v_add_f32 v152, v152, v153
    v_add_f32 v154, v154, v155
    v_mov_b32 v145, v144
    v_mov_b32 v147, v146
    v_mov_b32 v149, v148
    v_mov_b32 v151, v150
    v_mov_b32 v153, v152
    v_mov_b32 v155, v154
    buffer_load_dwordx4 v9, s[48:51], s91 offen offset:3072 lds
    v_permlane32_swap_b32 v144, v145
    v_permlane32_swap_b32 v146, v147
    v_permlane32_swap_b32 v148, v149
    v_permlane32_swap_b32 v150, v151
    v_permlane32_swap_b32 v152, v153
    v_permlane32_swap_b32 v154, v155
    s_add_u32 m0, s25, 131072
    s_add_u32 s91, s89, 65536
    buffer_load_dwordx4 v6, s[48:51], s91 offen offset:0 lds
    v_add_f32 v144, v144, v145
    v_add_f32 v146, v146, v147
    v_add_f32 v148, v148, v149
    v_add_f32 v150, v150, v151
    v_add_f32 v152, v152, v153
    v_add_f32 v154, v154, v155
    v_mul_f32 v144, 0x3b000000, v144
    v_mul_f32 v146, 0x3b000000, v146
    v_mul_f32 v148, 0x3b000000, v148
    v_mul_f32 v150, 0x3b000000, v150
    v_mul_f32 v152, 0x3b000000, v152
    v_mul_f32 v154, 0x3b000000, v154
    v_fma_f32 v146, -v144, v144, v146
    v_max_f32 v146, 0, v146
    v_add_f32 v146, 0x3727c5ac, v146
    v_rsq_f32 v145, v146
    v_fma_f32 v148, -v144, s80, v148
    v_mul_f32 v157, v146, v145
    v_fma_f32 v147, v148, v145, s82
    v_mul_f32 v149, s81, v144
    v_fma_f32 v149, -2.0, v152, v149
    v_fma_f32 v150, v144, v149, v150
    v_fma_f32 v154, -v144, s84, v154
    v_add_f32 v154, v154, v154
    v_fma_f32 v150, v150, v145, v154
    v_fma_f32 v150, v150, v145, s83
    v_fma_f32 v150, -v147, v147, v150
    v_max_f32 v150, 0, v150
    v_add_f32 v150, 0x3727c5ac, v150
    v_rsq_f32 v151, v150
    v_sub_f32 v156, 0, v144
    v_mul_f32 v150, v150, v151
    v_mul_f32 v158, -v147, v157
    v_mul_f32 v159, v157, v150
    v_mul_f32 v151, v145, v151
    v_mul_f32 v160, 0xc0135761, v151
    v_mul_f32 v161, v151, v151
    v_mul_f32 v161, v161, v151
    v_mul_f32 v161, 0xbdd2d3e8, v161
    v_mov_b32 v162, v159
    v_mov_b32 v163, 0
    s_lshl_b32 s69, s3, 9
    buffer_load_dwordx4 v7, s[48:51], s91 offen offset:1024 lds
    v_lshlrev_b32 v27, 5, v23
    v_add_u32 v27, 160768, v27
    v_add_u32 v29, s69, v27
    v_lshl_add_u32 v28, v24, 2, v27
    ds_write_b128 v29, v[156:159]
    ds_write_b128 v29, v[160:163] offset:16
    s_waitcnt lgkmcnt(0)
    s_barrier
    v_mfma_f32_16x16x32_bf16 v[168:171], a[52:55], v[72:75], v[168:171]
    buffer_load_dwordx4 v8, s[48:51], s91 offen offset:2048 lds
    v_mfma_f32_16x16x32_bf16 v[172:175], a[116:119], v[72:75], v[172:175]
    buffer_load_dwordx4 v9, s[48:51], s91 offen offset:3072 lds
    v_mfma_f32_16x16x32_bf16 v[176:179], a[180:183], v[72:75], v[176:179]
    ds_read_b32 v140, v28 offset:0
    s_waitcnt vmcnt(15)
    s_waitcnt vmcnt(11)
    s_barrier
    v_mfma_f32_16x16x32_bf16 v[180:183], a[52:55], v[76:79], v[180:183]
    ds_read_b128 v[64:67], v1 offset:32768
    v_mfma_f32_16x16x32_bf16 v[184:187], a[116:119], v[76:79], v[184:187]
    ds_read_b128 v[68:71], v1 offset:33792
    v_mfma_f32_16x16x32_bf16 v[188:191], a[180:183], v[76:79], v[188:191]
    global_load_dword v5, v61, s[0:1]
    v_mfma_f32_16x16x32_bf16 v[168:171], a[56:59], v[80:83], v[168:171]
    ds_read_b128 v[72:75], v1 offset:34816
    s_add_u32 m0, s25, 81920
    v_mfma_f32_16x16x32_bf16 v[172:175], a[120:123], v[80:83], v[172:175]
    ds_read_b128 v[76:79], v1 offset:35840
    s_add_u32 s91, s89, 98304
    v_mfma_f32_16x16x32_bf16 v[176:179], a[184:187], v[80:83], v[176:179]
    buffer_load_dwordx4 v6, s[48:51], s91 offen offset:0 lds
    v_mfma_f32_16x16x32_bf16 v[180:183], a[56:59], v[84:87], v[180:183]
    ds_read_b128 v[80:83], v1 offset:36864
    v_mfma_f32_16x16x32_bf16 v[184:187], a[120:123], v[84:87], v[184:187]
    buffer_load_dwordx4 v7, s[48:51], s91 offen offset:1024 lds
    v_mfma_f32_16x16x32_bf16 v[188:191], a[184:187], v[84:87], v[188:191]
    ds_read_b128 v[96:99], v27 offset:16
    v_mfma_f32_16x16x32_bf16 v[168:171], a[60:63], v[88:91], v[168:171]
    ds_read_b128 v[84:87], v1 offset:37888
    v_mfma_f32_16x16x32_bf16 v[172:175], a[124:127], v[88:91], v[172:175]
    buffer_load_dwordx4 v8, s[48:51], s91 offen offset:2048 lds
    v_mfma_f32_16x16x32_bf16 v[176:179], a[188:191], v[88:91], v[176:179]
    ds_read_b32 v141, v28 offset:512
    v_mfma_f32_16x16x32_bf16 v[180:183], a[60:63], v[92:95], v[180:183]
    ds_read_b128 v[88:91], v1 offset:38912
    v_mfma_f32_16x16x32_bf16 v[184:187], a[124:127], v[92:95], v[184:187]
    buffer_load_dwordx4 v9, s[48:51], s91 offen offset:3072 lds
    s_add_u32 m0, s25, 98304
    v_mfma_f32_16x16x32_bf16 v[188:191], a[188:191], v[92:95], v[188:191]
    ds_read_b128 v[100:103], v27 offset:528
    s_waitcnt lgkmcnt(8)
    v_mfma_f32_16x16x32_bf16 v[192:195], a[0:3], v[64:67], 0
    ds_read_b128 v[92:95], v1 offset:39936
    s_add_u32 s91, s89, 131072
    v_mfma_f32_16x16x32_bf16 v[196:199], a[64:67], v[64:67], 0
    ds_read_b32 v142, v28 offset:1024
    v_mfma_f32_16x16x32_bf16 v[200:203], a[128:131], v[64:67], 0
    ds_read_b128 v[104:107], v27 offset:1040
    ds_read_b32 v143, v28 offset:1536
    ds_read_b128 v[108:111], v27 offset:1552
    s_waitcnt lgkmcnt(0)
    v_cmp_eq_u32 vcc, 3, v24
    s_nop 1
    v_cndmask_b32 v128, v128, v55, vcc
    v_cndmask_b32 v132, v132, v56, vcc
    v_cndmask_b32 v136, v136, v57, vcc
    s_barrier
    v_subrev_u32 v10, 16384, v14
    v_subrev_u32 v11, 16384, v15
    v_subrev_u32 v12, 16384, v16
    v_subrev_u32 v13, 16384, v17
    v_mfma_f32_16x16x4_f32 v[168:171], v128, v140, v[168:171]
    buffer_load_dwordx4 v6, s[48:51], s91 offen offset:0 lds
    v_mfma_f32_16x16x4_f32 v[172:175], v132, v140, v[172:175]
    buffer_load_dwordx4 v7, s[48:51], s91 offen offset:1024 lds
    v_mfma_f32_16x16x4_f32 v[176:179], v136, v140, v[176:179]
    v_mfma_f32_16x16x4_f32 v[180:183], v128, v141, v[180:183]
    v_mfma_f32_16x16x4_f32 v[184:187], v132, v141, v[184:187]
    buffer_load_dwordx4 v8, s[48:51], s91 offen offset:2048 lds
    v_mfma_f32_16x16x4_f32 v[188:191], v136, v141, v[188:191]
    s_nop 1
    v_pk_mul_f32 v[216:217], v[168:169], v[168:169]
    buffer_load_dwordx4 v9, s[48:51], s91 offen offset:3072 lds
    v_pk_mul_f32 v[218:219], v[170:171], v[170:171]
    v_pk_mul_f32 v[220:221], v[172:173], v[172:173]
    v_pk_mul_f32 v[222:223], v[174:175], v[174:175]
    v_pk_mul_f32 v[224:225], v[176:177], v[176:177]
    v_pk_mul_f32 v[226:227], v[178:179], v[178:179]
    v_pk_fma_f32 v[216:217], v[216:217], v[96:97], v[96:97] op_sel:[0,1,0] op_sel_hi:[1,1,0]
    v_pk_fma_f32 v[218:219], v[218:219], v[96:97], v[96:97] op_sel:[0,1,0] op_sel_hi:[1,1,0]
    v_pk_fma_f32 v[220:221], v[220:221], v[96:97], v[96:97] op_sel:[0,1,0] op_sel_hi:[1,1,0]
    v_pk_fma_f32 v[222:223], v[222:223], v[96:97], v[96:97] op_sel:[0,1,0] op_sel_hi:[1,1,0]
    s_add_u32 m0, s25, 16384
    s_add_u32 s91, s89, 163840
    buffer_load_dwordx4 v6, s[48:51], s91 offen offset:0 lds
    v_pk_fma_f32 v[224:225], v[224:225], v[96:97], v[96:97] op_sel:[0,1,0] op_sel_hi:[1,1,0]
    v_pk_fma_f32 v[226:227], v[226:227], v[96:97], v[96:97] op_sel:[0,1,0] op_sel_hi:[1,1,0]
    v_pk_mul_f32 v[216:217], v[216:217], v[168:169]
    v_pk_mul_f32 v[218:219], v[218:219], v[170:171]
    v_pk_mul_f32 v[220:221], v[220:221], v[172:173]
    v_pk_mul_f32 v[222:223], v[222:223], v[174:175]
    v_pk_mul_f32 v[224:225], v[224:225], v[176:177]
    v_pk_mul_f32 v[226:227], v[226:227], v[178:179]
    v_exp_f32 v216, v216
    v_exp_f32 v217, v217
    buffer_load_dwordx4 v7, s[48:51], s91 offen offset:1024 lds
    v_exp_f32 v218, v218
    v_exp_f32 v219, v219
    v_exp_f32 v220, v220
    v_exp_f32 v221, v221
    v_exp_f32 v222, v222
    v_exp_f32 v223, v223
    buffer_load_dwordx4 v8, s[48:51], s91 offen offset:2048 lds
    v_exp_f32 v224, v224
    v_exp_f32 v225, v225
    v_exp_f32 v226, v226
    v_exp_f32 v227, v227
    v_pk_fma_f32 v[216:217], v[216:217], v[98:99], v[98:99] op_sel_hi:[1,0,0]
    v_pk_fma_f32 v[218:219], v[218:219], v[98:99], v[98:99] op_sel_hi:[1,0,0]
    buffer_load_dwordx4 v9, s[48:51], s91 offen offset:3072 lds
    v_pk_fma_f32 v[220:221], v[220:221], v[98:99], v[98:99] op_sel_hi:[1,0,0]
    v_pk_fma_f32 v[222:223], v[222:223], v[98:99], v[98:99] op_sel_hi:[1,0,0]
    v_pk_fma_f32 v[224:225], v[224:225], v[98:99], v[98:99] op_sel_hi:[1,0,0]
    v_pk_fma_f32 v[226:227], v[226:227], v[98:99], v[98:99] op_sel_hi:[1,0,0]
    v_rcp_f32 v216, v216
    v_rcp_f32 v217, v217
    v_rcp_f32 v218, v218
    v_rcp_f32 v219, v219
    v_rcp_f32 v220, v220
    v_rcp_f32 v221, v221
    v_rcp_f32 v222, v222
    v_rcp_f32 v223, v223
    v_rcp_f32 v224, v224
    v_rcp_f32 v225, v225
    v_rcp_f32 v226, v226
    v_rcp_f32 v227, v227
    v_pk_mul_f32 v[216:217], v[216:217], v[168:169]
    v_pk_mul_f32 v[218:219], v[218:219], v[170:171]
    v_pk_mul_f32 v[220:221], v[220:221], v[172:173]
    v_pk_mul_f32 v[222:223], v[222:223], v[174:175]
    v_pk_mul_f32 v[224:225], v[224:225], v[176:177]
    v_pk_mul_f32 v[226:227], v[226:227], v[178:179]
    v_cvt_pk_bf16_f32 v228, v216, v217
    v_cvt_pk_bf16_f32 v229, v218, v219
    v_cvt_pk_bf16_f32 v232, v220, v221
    v_cvt_pk_bf16_f32 v233, v222, v223
    v_cvt_pk_bf16_f32 v236, v224, v225
    v_cvt_pk_bf16_f32 v237, v226, v227
    v_pk_mul_f32 v[216:217], v[180:181], v[180:181]
    v_pk_mul_f32 v[218:219], v[182:183], v[182:183]
    v_pk_mul_f32 v[220:221], v[184:185], v[184:185]
    s_add_u32 m0, s25, 0
    s_add_u32 s91, s89, 196608
    buffer_load_dwordx4 v6, s[48:51], s91 offen offset:0 lds
    v_pk_mul_f32 v[222:223], v[186:187], v[186:187]
    v_pk_mul_f32 v[224:225], v[188:189], v[188:189]
    v_pk_mul_f32 v[226:227], v[190:191], v[190:191]
    v_pk_fma_f32 v[216:217], v[216:217], v[100:101], v[100:101] op_sel:[0,1,0] op_sel_hi:[1,1,0]
    v_pk_fma_f32 v[218:219], v[218:219], v[100:101], v[100:101] op_sel:[0,1,0] op_sel_hi:[1,1,0]
    v_pk_fma_f32 v[220:221], v[220:221], v[100:101], v[100:101] op_sel:[0,1,0] op_sel_hi:[1,1,0]
    v_pk_fma_f32 v[222:223], v[222:223], v[100:101], v[100:101] op_sel:[0,1,0] op_sel_hi:[1,1,0]
    v_pk_fma_f32 v[224:225], v[224:225], v[100:101], v[100:101] op_sel:[0,1,0] op_sel_hi:[1,1,0]
    v_pk_fma_f32 v[226:227], v[226:227], v[100:101], v[100:101] op_sel:[0,1,0] op_sel_hi:[1,1,0]
    v_pk_mul_f32 v[216:217], v[216:217], v[180:181]
    v_pk_mul_f32 v[218:219], v[218:219], v[182:183]
    v_pk_mul_f32 v[220:221], v[220:221], v[184:185]
    v_pk_mul_f32 v[222:223], v[222:223], v[186:187]
    v_pk_mul_f32 v[224:225], v[224:225], v[188:189]
    v_pk_mul_f32 v[226:227], v[226:227], v[190:191]
    buffer_load_dwordx4 v7, s[48:51], s91 offen offset:1024 lds
    v_exp_f32 v216, v216
    v_exp_f32 v217, v217
    v_exp_f32 v218, v218
    v_exp_f32 v219, v219
    v_exp_f32 v220, v220
    v_exp_f32 v221, v221
    v_exp_f32 v222, v222
    v_exp_f32 v223, v223
    v_exp_f32 v224, v224
    v_exp_f32 v225, v225
    v_exp_f32 v226, v226
    v_exp_f32 v227, v227
    v_pk_fma_f32 v[216:217], v[216:217], v[102:103], v[102:103] op_sel_hi:[1,0,0]
    v_pk_fma_f32 v[218:219], v[218:219], v[102:103], v[102:103] op_sel_hi:[1,0,0]
    v_pk_fma_f32 v[220:221], v[220:221], v[102:103], v[102:103] op_sel_hi:[1,0,0]
    v_pk_fma_f32 v[222:223], v[222:223], v[102:103], v[102:103] op_sel_hi:[1,0,0]
    v_pk_fma_f32 v[224:225], v[224:225], v[102:103], v[102:103] op_sel_hi:[1,0,0]
    v_pk_fma_f32 v[226:227], v[226:227], v[102:103], v[102:103] op_sel_hi:[1,0,0]
    v_rcp_f32 v216, v216
    v_rcp_f32 v217, v217
    v_rcp_f32 v218, v218
    buffer_load_dwordx4 v8, s[48:51], s91 offen offset:2048 lds
    v_rcp_f32 v219, v219
    v_rcp_f32 v220, v220
    v_rcp_f32 v221, v221
    v_rcp_f32 v222, v222
    v_rcp_f32 v223, v223
    v_rcp_f32 v224, v224
    buffer_load_dwordx4 v9, s[48:51], s91 offen offset:3072 lds
    v_rcp_f32 v225, v225
    v_rcp_f32 v226, v226
    v_rcp_f32 v227, v227
    v_pk_mul_f32 v[216:217], v[216:217], v[180:181]
    v_pk_mul_f32 v[218:219], v[218:219], v[182:183]
    v_pk_mul_f32 v[220:221], v[220:221], v[184:185]
    v_pk_mul_f32 v[222:223], v[222:223], v[186:187]
    v_pk_mul_f32 v[224:225], v[224:225], v[188:189]
    v_pk_mul_f32 v[226:227], v[226:227], v[190:191]
    v_cvt_pk_bf16_f32 v230, v216, v217
    v_cvt_pk_bf16_f32 v231, v218, v219
    v_cvt_pk_bf16_f32 v234, v220, v221
    v_cvt_pk_bf16_f32 v235, v222, v223
    v_cvt_pk_bf16_f32 v238, v224, v225
    v_cvt_pk_bf16_f32 v239, v226, v227
    v_permlane16_swap_b32 v228, v230
    v_permlane16_swap_b32 v229, v231
    v_permlane16_swap_b32 v232, v234
    v_permlane16_swap_b32 v233, v235
    v_permlane16_swap_b32 v236, v238
    v_permlane16_swap_b32 v237, v239
    buffer_store_dwordx4 v[228:231], v38, s[52:55], s98 offen offset:0 sc1
    buffer_store_dwordx4 v[232:235], v38, s[52:55], s98 offen offset:512 sc1
    buffer_store_dwordx4 v[236:239], v38, s[52:55], s98 offen offset:1024 sc1
    s_waitcnt vmcnt(28)
    v_mfma_f32_16x16x32_bf16 v[192:195], a[4:7], v[68:71], v[192:195]
    ds_read_b128 v[64:67], v1 offset:40960
    v_mfma_f32_16x16x32_bf16 v[196:199], a[68:71], v[68:71], v[196:199]
    ds_read_b64_tr_b16 a[192:193], v19 offset:32768
    v_mfma_f32_16x16x32_bf16 v[200:203], a[132:135], v[68:71], v[200:203]
    ds_read_b64_tr_b16 a[194:195], v19 offset:33280
    v_mfma_f32_16x16x32_bf16 v[192:195], a[8:11], v[72:75], v[192:195]
    ds_read_b128 v[68:71], v1 offset:41984
    v_mfma_f32_16x16x32_bf16 v[196:199], a[72:75], v[72:75], v[196:199]
    ds_read_b64_tr_b16 a[196:197], v20 offset:32768
    v_mfma_f32_16x16x32_bf16 v[200:203], a[136:139], v[72:75], v[200:203]
    ds_read_b64_tr_b16 a[198:199], v20 offset:33280
    v_mfma_f32_16x16x32_bf16 v[192:195], a[12:15], v[76:79], v[192:195]
    ds_read_b128 v[72:75], v1 offset:43008
    v_mfma_f32_16x16x32_bf16 v[196:199], a[76:79], v[76:79], v[196:199]
    ds_read_b64_tr_b16 a[200:201], v21 offset:32768
    v_mfma_f32_16x16x32_bf16 v[200:203], a[140:143], v[76:79], v[200:203]
    ds_read_b64_tr_b16 a[202:203], v21 offset:33280
    v_mfma_f32_16x16x32_bf16 v[192:195], a[16:19], v[80:83], v[192:195]
    ds_read_b128 v[76:79], v1 offset:44032
    v_mfma_f32_16x16x32_bf16 v[196:199], a[80:83], v[80:83], v[196:199]
    ds_read_b64_tr_b16 a[204:205], v22 offset:32768
    v_mfma_f32_16x16x32_bf16 v[200:203], a[144:147], v[80:83], v[200:203]
    ds_read_b64_tr_b16 a[206:207], v22 offset:33280
    s_waitcnt vmcnt(24)
    v_mfma_f32_16x16x32_bf16 v[192:195], a[20:23], v[84:87], v[192:195]
    ds_read_b128 v[80:83], v1 offset:45056
    v_mfma_f32_16x16x32_bf16 v[196:199], a[84:87], v[84:87], v[196:199]
    ds_read_b64_tr_b16 a[208:209], v14 offset:49152
    v_mfma_f32_16x16x32_bf16 v[200:203], a[148:151], v[84:87], v[200:203]
    ds_read_b64_tr_b16 a[210:211], v14 offset:49664
    v_mfma_f32_16x16x32_bf16 v[192:195], a[24:27], v[88:91], v[192:195]
    ds_read_b128 v[84:87], v1 offset:46080
    v_mfma_f32_16x16x32_bf16 v[196:199], a[88:91], v[88:91], v[196:199]
    ds_read_b64_tr_b16 a[212:213], v15 offset:49152
    v_mfma_f32_16x16x32_bf16 v[200:203], a[152:155], v[88:91], v[200:203]
    ds_read_b64_tr_b16 a[214:215], v15 offset:49664
    v_mfma_f32_16x16x32_bf16 v[192:195], a[28:31], v[92:95], v[192:195]
    ds_read_b128 v[88:91], v1 offset:47104
    v_mfma_f32_16x16x32_bf16 v[196:199], a[92:95], v[92:95], v[196:199]
    ds_read_b64_tr_b16 a[216:217], v16 offset:49152
    v_mfma_f32_16x16x32_bf16 v[200:203], a[156:159], v[92:95], v[200:203]
    ds_read_b64_tr_b16 a[218:219], v16 offset:49664
    s_waitcnt lgkmcnt(9)
    v_mfma_f32_16x16x32_bf16 v[192:195], a[32:35], v[64:67], v[192:195]
    ds_read_b128 v[92:95], v1 offset:48128
    s_add_u32 m0, s25, 114688
    v_mfma_f32_16x16x32_bf16 v[196:199], a[96:99], v[64:67], v[196:199]
    ds_read_b64_tr_b16 a[220:221], v17 offset:49152
    s_add_u32 s91, s89, 229376
    v_mfma_f32_16x16x32_bf16 v[200:203], a[160:163], v[64:67], v[200:203]
    buffer_load_dwordx4 v6, s[48:51], s91 offen offset:0 lds
    v_mfma_f32_16x16x32_bf16 v[192:195], a[36:39], v[68:71], v[192:195]
    ds_read_b128 v[64:67], v1 offset:49152
    v_mfma_f32_16x16x32_bf16 v[196:199], a[100:103], v[68:71], v[196:199]
    buffer_load_dwordx4 v7, s[48:51], s91 offen offset:1024 lds
    v_mfma_f32_16x16x32_bf16 v[200:203], a[164:167], v[68:71], v[200:203]
    buffer_load_dwordx4 v8, s[48:51], s91 offen offset:2048 lds
    v_mfma_f32_16x16x32_bf16 v[192:195], a[40:43], v[72:75], v[192:195]
    ds_read_b128 v[68:71], v1 offset:50176
    v_mfma_f32_16x16x32_bf16 v[196:199], a[104:107], v[72:75], v[196:199]
    buffer_load_dwordx4 v9, s[48:51], s91 offen offset:3072 lds
    v_mfma_f32_16x16x32_bf16 v[200:203], a[168:171], v[72:75], v[200:203]
    ds_read_b64_tr_b16 a[222:223], v17 offset:49664
    s_waitcnt vmcnt(24)
    v_mfma_f32_16x16x32_bf16 v[192:195], a[44:47], v[76:79], v[192:195]
    ds_read_b128 v[72:75], v1 offset:51200
    v_mfma_f32_16x16x32_bf16 v[196:199], a[108:111], v[76:79], v[196:199]
    ds_read_b64_tr_b16 a[224:225], v19 offset:49152
    v_mfma_f32_16x16x32_bf16 v[200:203], a[172:175], v[76:79], v[200:203]
    ds_read_b64_tr_b16 a[226:227], v19 offset:49664
    s_waitcnt lgkmcnt(13)
    v_mfma_f32_16x16x32_bf16 v[192:195], a[48:51], v[80:83], v[192:195]
    ds_read_b128 v[76:79], v1 offset:52224
    v_mfma_f32_16x16x32_bf16 v[196:199], a[112:115], v[80:83], v[196:199]
    ds_read_b64_tr_b16 a[228:229], v20 offset:49152
    v_mfma_f32_16x16x32_bf16 v[200:203], a[176:179], v[80:83], v[200:203]
    ds_read_b64_tr_b16 a[230:231], v20 offset:49664
    v_mfma_f32_16x16x32_bf16 v[192:195], a[52:55], v[84:87], v[192:195]
    ds_read_b128 v[80:83], v1 offset:53248
    v_mfma_f32_16x16x32_bf16 v[196:199], a[116:119], v[84:87], v[196:199]
    ds_read_b64_tr_b16 a[232:233], v21 offset:49152
    v_mfma_f32_16x16x32_bf16 v[200:203], a[180:183], v[84:87], v[200:203]
    ds_read_b64_tr_b16 a[234:235], v21 offset:49664
    s_waitcnt lgkmcnt(9)
    v_mfma_f32_16x16x32_bf16 v[192:195], a[56:59], v[88:91], v[192:195]
    ds_read_b128 v[84:87], v1 offset:54272
    s_add_u32 m0, s25, 65536
    v_mfma_f32_16x16x32_bf16 v[196:199], a[120:123], v[88:91], v[196:199]
    ds_read_b64_tr_b16 a[236:237], v22 offset:49152
    s_add_u32 s91, s89, 262144
    v_mfma_f32_16x16x32_bf16 v[200:203], a[184:187], v[88:91], v[200:203]
    buffer_load_dwordx4 v6, s[48:51], s91 offen offset:0 lds
    v_mfma_f32_16x16x32_bf16 v[192:195], a[60:63], v[92:95], v[192:195]
    ds_read_b128 v[88:91], v1 offset:55296
    v_mfma_f32_16x16x32_bf16 v[196:199], a[124:127], v[92:95], v[196:199]
    buffer_load_dwordx4 v7, s[48:51], s91 offen offset:1024 lds
    v_mfma_f32_16x16x32_bf16 v[200:203], a[188:191], v[92:95], v[200:203]
    buffer_load_dwordx4 v8, s[48:51], s91 offen offset:2048 lds
    v_mfma_f32_16x16x32_bf16 v[204:207], a[0:3], v[64:67], 0
    ds_read_b128 v[92:95], v1 offset:56320
    v_mfma_f32_16x16x32_bf16 v[208:211], a[64:67], v[64:67], 0
    buffer_load_dwordx4 v9, s[48:51], s91 offen offset:3072 lds
    v_mfma_f32_16x16x32_bf16 v[212:215], a[128:131], v[64:67], 0
    ds_read_b64_tr_b16 a[238:239], v22 offset:49664
    s_waitcnt vmcnt(23)
    v_mfma_f32_16x16x32_bf16 v[204:207], a[4:7], v[68:71], v[204:207]
    ds_read_b128 v[64:67], v1 offset:57344
    v_mfma_f32_16x16x32_bf16 v[208:211], a[68:71], v[68:71], v[208:211]
    ds_read_b64_tr_b16 a[240:241], v19 offset:0
    v_mfma_f32_16x16x32_bf16 v[212:215], a[132:135], v[68:71], v[212:215]
    ds_read_b64_tr_b16 a[242:243], v19 offset:512
    v_mfma_f32_16x16x4_f32 v[192:195], v128, v142, v[192:195]
    ds_read_b64_tr_b16 a[244:245], v20 offset:0
    v_mfma_f32_16x16x4_f32 v[196:199], v132, v142, v[196:199]
    ds_read_b64_tr_b16 a[246:247], v20 offset:512
    v_mfma_f32_16x16x4_f32 v[200:203], v136, v142, v[200:203]
    ds_read_b64_tr_b16 a[248:249], v21 offset:0
    s_waitcnt lgkmcnt(6)
    v_mfma_f32_16x16x32_bf16 v[204:207], a[8:11], v[72:75], v[204:207]
    ds_read_b128 v[68:71], v1 offset:58368
    s_add_u32 m0, s25, 131072
    v_mfma_f32_16x16x32_bf16 v[208:211], a[72:75], v[72:75], v[208:211]
    ds_read_b64_tr_b16 a[250:251], v21 offset:512
    s_add_u32 s91, s89, 294912
    v_mfma_f32_16x16x32_bf16 v[212:215], a[136:139], v[72:75], v[212:215]
    buffer_load_dwordx4 v6, s[48:51], s91 offen offset:0 lds
    v_mfma_f32_16x16x32_bf16 v[204:207], a[12:15], v[76:79], v[204:207]
    ds_read_b128 v[72:75], v1 offset:59392
    v_mfma_f32_16x16x32_bf16 v[208:211], a[76:79], v[76:79], v[208:211]
    ds_read_b64_tr_b16 a[252:253], v22 offset:0
    v_mfma_f32_16x16x32_bf16 v[212:215], a[140:143], v[76:79], v[212:215]
    buffer_load_dwordx4 v7, s[48:51], s91 offen offset:1024 lds
    v_mfma_f32_16x16x32_bf16 v[204:207], a[16:19], v[80:83], v[204:207]
    ds_read_b128 v[76:79], v1 offset:60416
    v_pk_mul_f32 v[216:217], v[192:193], v[192:193]
    v_pk_mul_f32 v[218:219], v[194:195], v[194:195]
    v_pk_mul_f32 v[220:221], v[196:197], v[196:197]
    v_pk_mul_f32 v[222:223], v[198:199], v[198:199]
    v_pk_mul_f32 v[224:225], v[200:201], v[200:201]
    v_pk_mul_f32 v[226:227], v[202:203], v[202:203]
    v_pk_fma_f32 v[216:217], v[216:217], v[104:105], v[104:105] op_sel:[0,1,0] op_sel_hi:[1,1,0]
    v_pk_fma_f32 v[218:219], v[218:219], v[104:105], v[104:105] op_sel:[0,1,0] op_sel_hi:[1,1,0]
    v_pk_fma_f32 v[220:221], v[220:221], v[104:105], v[104:105] op_sel:[0,1,0] op_sel_hi:[1,1,0]
    v_pk_fma_f32 v[222:223], v[222:223], v[104:105], v[104:105] op_sel:[0,1,0] op_sel_hi:[1,1,0]
    v_pk_fma_f32 v[224:225], v[224:225], v[104:105], v[104:105] op_sel:[0,1,0] op_sel_hi:[1,1,0]
    v_pk_fma_f32 v[226:227], v[226:227], v[104:105], v[104:105] op_sel:[0,1,0] op_sel_hi:[1,1,0]
    v_pk_mul_f32 v[216:217], v[216:217], v[192:193]
    v_pk_mul_f32 v[218:219], v[218:219], v[194:195]
    v_pk_mul_f32 v[220:221], v[220:221], v[196:197]
    v_pk_mul_f32 v[222:223], v[222:223], v[198:199]
    v_pk_mul_f32 v[224:225], v[224:225], v[200:201]
    v_pk_mul_f32 v[226:227], v[226:227], v[202:203]
    v_mfma_f32_16x16x32_bf16 v[208:211], a[80:83], v[80:83], v[208:211]
    buffer_load_dwordx4 v8, s[48:51], s91 offen offset:2048 lds
    v_mfma_f32_16x16x32_bf16 v[212:215], a[144:147], v[80:83], v[212:215]
    buffer_load_dwordx4 v9, s[48:51], s91 offen offset:3072 lds
    s_waitcnt vmcnt(12)
    s_barrier
    s_cmp_lg_u32 s3, 0
    s_cbranch_scc1 Lpub_38
    s_add_u32 s20, s66, 6
    v_mov_b32 v60, s20
    s_mov_b64 exec, 1
    s_cmp_eq_u32 s67, 1
    s_cbranch_scc1 Lpub_39
    buffer_store_dword v60, v41, s[52:55], s17 offen offset:160 sc1
    s_mov_b64 exec, -1
    s_branch Lpub_38
Lpub_39:
    buffer_store_dword v60, v41, s[52:55], s17 offen offset:160
    s_mov_b64 exec, -1
Lpub_38:
    v_mfma_f32_16x16x32_bf16 v[204:207], a[20:23], v[84:87], v[204:207]
    ds_read_b128 v[80:83], v1 offset:61440
    v_mfma_f32_16x16x32_bf16 v[208:211], a[84:87], v[84:87], v[208:211]
    ds_read_b64_tr_b16 a[254:255], v22 offset:512
    v_mfma_f32_16x16x32_bf16 v[212:215], a[148:151], v[84:87], v[212:215]
    v_mfma_f32_16x16x32_bf16 v[204:207], a[24:27], v[88:91], v[204:207]
    ds_read_b128 v[84:87], v1 offset:62464
    v_mfma_f32_16x16x32_bf16 v[208:211], a[88:91], v[88:91], v[208:211]
    v_exp_f32 v216, v216
    v_mfma_f32_16x16x32_bf16 v[212:215], a[152:155], v[88:91], v[212:215]
    v_exp_f32 v217, v217
    v_mfma_f32_16x16x32_bf16 v[204:207], a[28:31], v[92:95], v[204:207]
    ds_read_b128 v[88:91], v1 offset:63488
    v_mfma_f32_16x16x32_bf16 v[208:211], a[92:95], v[92:95], v[208:211]
    v_exp_f32 v218, v218
    v_mfma_f32_16x16x32_bf16 v[212:215], a[156:159], v[92:95], v[212:215]
    s_waitcnt lgkmcnt(2)
    v_mfma_f32_16x16x32_bf16 v[204:207], a[32:35], v[64:67], v[204:207]
    ds_read_b128 v[92:95], v1 offset:64512
    s_add_u32 m0, s25, 81920
    v_mfma_f32_16x16x32_bf16 v[208:211], a[96:99], v[64:67], v[208:211]
    s_mov_b32 s91, s78
    v_mfma_f32_16x16x32_bf16 v[212:215], a[160:163], v[64:67], v[212:215]
    buffer_load_dwordx4 v6, s[48:51], s91 offen offset:0 lds
    v_mfma_f32_16x16x32_bf16 v[204:207], a[36:39], v[68:71], v[204:207]
    buffer_load_dwordx4 v7, s[48:51], s91 offen offset:1024 lds
    v_mfma_f32_16x16x32_bf16 v[208:211], a[100:103], v[68:71], v[208:211]
    buffer_load_dwordx4 v8, s[48:51], s91 offen offset:2048 lds
    v_mfma_f32_16x16x32_bf16 v[212:215], a[164:167], v[68:71], v[212:215]
    buffer_load_dwordx4 v9, s[48:51], s91 offen offset:3072 lds
    v_mfma_f32_16x16x32_bf16 v[204:207], a[40:43], v[72:75], v[204:207]
    v_exp_f32 v219, v219
    v_mfma_f32_16x16x32_bf16 v[208:211], a[104:107], v[72:75], v[208:211]
    v_exp_f32 v220, v220
    v_mfma_f32_16x16x32_bf16 v[212:215], a[168:171], v[72:75], v[212:215]
    v_exp_f32 v221, v221
    v_mfma_f32_16x16x32_bf16 v[204:207], a[44:47], v[76:79], v[204:207]
    v_exp_f32 v222, v222
    v_mfma_f32_16x16x32_bf16 v[208:211], a[108:111], v[76:79], v[208:211]
    v_exp_f32 v223, v223
    v_mfma_f32_16x16x32_bf16 v[212:215], a[172:175], v[76:79], v[212:215]
    s_waitcnt lgkmcnt(2)
    v_mfma_f32_16x16x32_bf16 v[204:207], a[48:51], v[80:83], v[204:207]
    v_exp_f32 v224, v224
    v_mfma_f32_16x16x32_bf16 v[208:211], a[112:115], v[80:83], v[208:211]
    v_exp_f32 v225, v225
    v_mfma_f32_16x16x32_bf16 v[212:215], a[176:179], v[80:83], v[212:215]
    v_exp_f32 v226, v226
    v_mfma_f32_16x16x32_bf16 v[204:207], a[52:55], v[84:87], v[204:207]
    v_exp_f32 v227, v227
    v_mfma_f32_16x16x32_bf16 v[208:211], a[116:119], v[84:87], v[208:211]
    v_pk_fma_f32 v[216:217], v[216:217], v[106:107], v[106:107] op_sel_hi:[1,0,0]
    v_pk_fma_f32 v[218:219], v[218:219], v[106:107], v[106:107] op_sel_hi:[1,0,0]
    v_pk_fma_f32 v[220:221], v[220:221], v[106:107], v[106:107] op_sel_hi:[1,0,0]
    v_pk_fma_f32 v[222:223], v[222:223], v[106:107], v[106:107] op_sel_hi:[1,0,0]
    v_pk_fma_f32 v[224:225], v[224:225], v[106:107], v[106:107] op_sel_hi:[1,0,0]
    v_pk_fma_f32 v[226:227], v[226:227], v[106:107], v[106:107] op_sel_hi:[1,0,0]
    v_mfma_f32_16x16x32_bf16 v[212:215], a[180:183], v[84:87], v[212:215]
    buffer_load_dword v40, v39, s[52:55], s17 offen offset:160 sc1
    s_waitcnt lgkmcnt(0)
    v_mfma_f32_16x16x32_bf16 v[204:207], a[56:59], v[88:91], v[204:207]
    v_rcp_f32 v216, v216
    v_mfma_f32_16x16x32_bf16 v[208:211], a[120:123], v[88:91], v[208:211]
    v_rcp_f32 v217, v217
    v_mfma_f32_16x16x32_bf16 v[212:215], a[184:187], v[88:91], v[212:215]
    v_rcp_f32 v218, v218
    v_mfma_f32_16x16x32_bf16 v[204:207], a[60:63], v[92:95], v[204:207]
    v_rcp_f32 v219, v219
    v_mfma_f32_16x16x32_bf16 v[208:211], a[124:127], v[92:95], v[208:211]
    v_rcp_f32 v220, v220
    v_mfma_f32_16x16x32_bf16 v[212:215], a[188:191], v[92:95], v[212:215]
    s_nop 1
    v_mfma_f32_16x16x4_f32 v[204:207], v128, v143, v[204:207]
    v_rcp_f32 v221, v221
    v_rcp_f32 v222, v222
    v_mfma_f32_16x16x4_f32 v[208:211], v132, v143, v[208:211]
    v_rcp_f32 v223, v223
    v_rcp_f32 v224, v224
    v_mfma_f32_16x16x4_f32 v[212:215], v136, v143, v[212:215]
    v_rcp_f32 v225, v225
    v_rcp_f32 v226, v226
    s_barrier
    v_rcp_f32 v227, v227
    v_pk_mul_f32 v[216:217], v[216:217], v[192:193]
    v_pk_mul_f32 v[218:219], v[218:219], v[194:195]
    v_pk_mul_f32 v[220:221], v[220:221], v[196:197]
    v_pk_mul_f32 v[222:223], v[222:223], v[198:199]
    v_pk_mul_f32 v[224:225], v[224:225], v[200:201]
    v_pk_mul_f32 v[226:227], v[226:227], v[202:203]
    v_cvt_pk_bf16_f32 v236, v216, v217
    v_cvt_pk_bf16_f32 v237, v218, v219
    v_cvt_pk_bf16_f32 v238, v220, v221
    v_cvt_pk_bf16_f32 v239, v222, v223
    v_cvt_pk_bf16_f32 v240, v224, v225
    v_cvt_pk_bf16_f32 v241, v226, v227
    v_permlane16_swap_b32 v236, v238
    v_permlane16_swap_b32 v237, v239
    v_permlane16_swap_b32 v240, v242
    v_permlane16_swap_b32 v241, v243
    buffer_store_dwordx4 v[236:239], v62, s[52:55], s77 offen sc1
    buffer_store_dwordx4 v[240:243], v63, s[52:55], s77 offen offset:1024 sc1
    v_pk_mul_f32 v[216:217], v[204:205], v[204:205]
    v_pk_mul_f32 v[218:219], v[206:207], v[206:207]
    v_pk_mul_f32 v[220:221], v[208:209], v[208:209]
    v_pk_mul_f32 v[222:223], v[210:211], v[210:211]
    v_pk_mul_f32 v[224:225], v[212:213], v[212:213]
    v_pk_mul_f32 v[226:227], v[214:215], v[214:215]
    v_pk_fma_f32 v[216:217], v[216:217], v[108:109], v[108:109] op_sel:[0,1,0] op_sel_hi:[1,1,0]
    v_pk_fma_f32 v[218:219], v[218:219], v[108:109], v[108:109] op_sel:[0,1,0] op_sel_hi:[1,1,0]
    v_pk_fma_f32 v[220:221], v[220:221], v[108:109], v[108:109] op_sel:[0,1,0] op_sel_hi:[1,1,0]
    v_pk_fma_f32 v[222:223], v[222:223], v[108:109], v[108:109] op_sel:[0,1,0] op_sel_hi:[1,1,0]
    v_pk_fma_f32 v[224:225], v[224:225], v[108:109], v[108:109] op_sel:[0,1,0] op_sel_hi:[1,1,0]
    v_pk_fma_f32 v[226:227], v[226:227], v[108:109], v[108:109] op_sel:[0,1,0] op_sel_hi:[1,1,0]
    v_pk_mul_f32 v[216:217], v[216:217], v[204:205]
    v_pk_mul_f32 v[218:219], v[218:219], v[206:207]
    v_pk_mul_f32 v[220:221], v[220:221], v[208:209]
    v_pk_mul_f32 v[222:223], v[222:223], v[210:211]
    v_pk_mul_f32 v[224:225], v[224:225], v[212:213]
    v_pk_mul_f32 v[226:227], v[226:227], v[214:215]
    v_exp_f32 v216, v216
    v_exp_f32 v217, v217
    v_exp_f32 v218, v218
    v_exp_f32 v219, v219
    v_exp_f32 v220, v220
    v_exp_f32 v221, v221
    v_exp_f32 v222, v222
    v_exp_f32 v223, v223
    v_exp_f32 v224, v224
    v_exp_f32 v225, v225
    v_exp_f32 v226, v226
    v_exp_f32 v227, v227
    v_pk_fma_f32 v[216:217], v[216:217], v[110:111], v[110:111] op_sel_hi:[1,0,0]
    v_pk_fma_f32 v[218:219], v[218:219], v[110:111], v[110:111] op_sel_hi:[1,0,0]
    v_pk_fma_f32 v[220:221], v[220:221], v[110:111], v[110:111] op_sel_hi:[1,0,0]
    v_pk_fma_f32 v[222:223], v[222:223], v[110:111], v[110:111] op_sel_hi:[1,0,0]
    v_pk_fma_f32 v[224:225], v[224:225], v[110:111], v[110:111] op_sel_hi:[1,0,0]
    v_pk_fma_f32 v[226:227], v[226:227], v[110:111], v[110:111] op_sel_hi:[1,0,0]
    v_rcp_f32 v216, v216
    v_rcp_f32 v217, v217
    v_rcp_f32 v218, v218
    v_rcp_f32 v219, v219
    v_rcp_f32 v220, v220
    v_rcp_f32 v221, v221
    v_rcp_f32 v222, v222
    v_rcp_f32 v223, v223
    v_rcp_f32 v224, v224
    v_rcp_f32 v225, v225
    v_rcp_f32 v226, v226
    v_rcp_f32 v227, v227
    v_pk_mul_f32 v[216:217], v[216:217], v[204:205]
    v_pk_mul_f32 v[218:219], v[218:219], v[206:207]
    v_pk_mul_f32 v[220:221], v[220:221], v[208:209]
    v_pk_mul_f32 v[222:223], v[222:223], v[210:211]
    v_pk_mul_f32 v[224:225], v[224:225], v[212:213]
    v_pk_mul_f32 v[226:227], v[226:227], v[214:215]
    v_cvt_pk_bf16_f32 v244, v216, v217
    v_cvt_pk_bf16_f32 v245, v218, v219
    v_cvt_pk_bf16_f32 v246, v220, v221
    v_cvt_pk_bf16_f32 v247, v222, v223
    v_cvt_pk_bf16_f32 v248, v224, v225
    v_cvt_pk_bf16_f32 v249, v226, v227
    s_add_u32 s77, s77, 44032
    v_permlane16_swap_b32 v244, v246
    v_permlane16_swap_b32 v245, v247
    s_add_u32 s20, s66, 6
    s_waitcnt vmcnt(2)
    v_cmp_ne_u32 s[28:29], s20, v40
    s_nop 0
    s_cmp_eq_u64 s[28:29], 0
    s_cbranch_scc1 Lwok_41
Lw_40:
    buffer_load_dword v40, v39, s[52:55], s17 offen offset:160 sc1
    s_waitcnt vmcnt(0)
    v_cmp_ne_u32 s[28:29], s20, v40
    s_nop 0
    s_cmp_eq_u64 s[28:29], 0
    s_cbranch_scc1 Lwok_41
    s_add_u32 s85, s85, 1
    s_cmp_lt_u32 s85, 400000
    s_cbranch_scc1 Lw_40
Lwok_41:
    buffer_load_dwordx4 v[144:147], v1, s[52:55], s4 offen offset:0 sc1
    v_permlane16_swap_b32 v248, v250
    v_permlane16_swap_b32 v249, v251
    buffer_store_dwordx4 v[244:247], v62, s[52:55], s77 offen sc1
    buffer_store_dwordx4 v[248:251], v63, s[52:55], s77 offen offset:1024 sc1
    ds_read_b64 v[138:139], v42 offset:5120
    buffer_load_dwordx4 v[148:151], v1, s[52:55], s7 offen offset:0 sc1
    v_lshlrev_b32 v25, 3, v24
    buffer_load_dwordx4 v[152:155], v1, s[52:55], s4 offen offset:1024 sc1
    s_lshl_b32 s69, s3, 5
    s_add_u32 s69, s69, 163072
    v_add_u32 v25, s69, v25
    ds_read_b64 v[134:135], v25
    ds_read_b64_tr_b16 a[0:1], v19 offset:16384
    ds_read_b64_tr_b16 a[2:3], v19 offset:16896
    ds_read_b64_tr_b16 a[4:5], v20 offset:16384
    ds_read_b64_tr_b16 a[6:7], v20 offset:16896
    ds_read_b64_tr_b16 a[8:9], v21 offset:16384
    ds_read_b64_tr_b16 a[10:11], v21 offset:16896
    buffer_load_dwordx4 v[156:159], v1, s[52:55], s7 offen offset:1024 sc1
    ds_read_b64_tr_b16 a[12:13], v22 offset:16384
    ds_read_b64_tr_b16 a[14:15], v22 offset:16896
    ds_read_b64_tr_b16 a[16:17], v14 offset:0
    ds_read_b64_tr_b16 a[18:19], v14 offset:512
    ds_read_b64_tr_b16 a[20:21], v15 offset:0
    ds_read_b64_tr_b16 a[22:23], v15 offset:512
    ds_read_b64_tr_b16 a[24:25], v16 offset:0
    ds_read_b64_tr_b16 a[26:27], v16 offset:512
    ds_read_b64_tr_b16 a[28:29], v17 offset:0
    buffer_load_dwordx4 v[160:163], v1, s[52:55], s4 offen offset:2048 sc1
    ds_read_b64_tr_b16 a[30:31], v17 offset:512
    ds_read_b64_tr_b16 a[32:33], v10 offset:0
    ds_read_b64_tr_b16 a[34:35], v10 offset:512
    ds_read_b64_tr_b16 a[36:37], v11 offset:0
    ds_read_b64_tr_b16 a[38:39], v11 offset:512
    ds_read_b64_tr_b16 a[40:41], v12 offset:0
    ds_read_b64_tr_b16 a[42:43], v12 offset:512
    ds_read_b64_tr_b16 a[44:45], v13 offset:0
    buffer_load_dwordx4 v[164:167], v1, s[52:55], s7 offen offset:2048 sc1
    ds_read_b64_tr_b16 a[46:47], v13 offset:512
    ds_read_b64_tr_b16 a[48:49], v19 offset:32768
    ds_read_b64_tr_b16 a[50:51], v19 offset:33280
    ds_read_b64_tr_b16 a[52:53], v20 offset:32768
    ds_read_b64_tr_b16 a[54:55], v20 offset:33280
    ds_read_b64_tr_b16 a[56:57], v21 offset:32768
    ds_read_b64_tr_b16 a[58:59], v21 offset:33280
    ds_read_b64_tr_b16 a[60:61], v22 offset:32768
    buffer_load_dwordx4 v[168:171], v1, s[52:55], s4 offen offset:3072 sc1
    ds_read_b64_tr_b16 a[62:63], v22 offset:33280
    ds_read_b64_tr_b16 a[64:65], v14 offset:49152
    ds_read_b64_tr_b16 a[66:67], v14 offset:49664
    ds_read_b64_tr_b16 a[68:69], v15 offset:49152
    ds_read_b64_tr_b16 a[70:71], v15 offset:49664
    ds_read_b64_tr_b16 a[72:73], v16 offset:49152
    ds_read_b64_tr_b16 a[74:75], v16 offset:49664
    ds_read_b64_tr_b16 a[76:77], v17 offset:49152
    buffer_load_dwordx4 v[172:175], v1, s[52:55], s7 offen offset:3072 sc1
    ds_read_b64_tr_b16 a[78:79], v17 offset:49664
    ds_read_b64_tr_b16 a[80:81], v19 offset:49152
    ds_read_b64_tr_b16 a[82:83], v19 offset:49664
    ds_read_b64_tr_b16 a[84:85], v20 offset:49152
    ds_read_b64_tr_b16 a[86:87], v20 offset:49664
    ds_read_b64_tr_b16 a[88:89], v21 offset:49152
    ds_read_b64_tr_b16 a[90:91], v21 offset:49664
    ds_read_b64_tr_b16 a[92:93], v22 offset:49152
    buffer_load_dwordx4 v[176:179], v1, s[52:55], s5 offen offset:0 sc1
    ds_read_b64_tr_b16 a[94:95], v22 offset:49664
    ds_read_b64_tr_b16 a[96:97], v19 offset:0
    ds_read_b64_tr_b16 a[98:99], v19 offset:512
    ds_read_b64_tr_b16 a[100:101], v20 offset:0
    ds_read_b64_tr_b16 a[102:103], v20 offset:512
    ds_read_b64_tr_b16 a[104:105], v21 offset:0
    s_waitcnt vmcnt(11)
    s_barrier
    s_cmp_lg_u32 s3, 0
    s_cbranch_scc1 Lpub_42
    s_add_u32 s20, s66, 7
    v_mov_b32 v60, s20
    s_mov_b64 exec, 1
    s_cmp_eq_u32 s67, 1
    s_cbranch_scc1 Lpub_43
    buffer_store_dword v60, v41, s[52:55], s17 offen offset:192 sc1
    s_mov_b64 exec, -1
    s_branch Lpub_42
Lpub_43:
    buffer_store_dword v60, v41, s[52:55], s17 offen offset:192
    s_mov_b64 exec, -1
Lpub_42:
    ds_read_b64_tr_b16 a[106:107], v21 offset:512
    ds_read_b64_tr_b16 a[108:109], v22 offset:0
    ds_read_b64_tr_b16 a[110:111], v22 offset:512
    buffer_load_dwordx4 v[180:183], v1, s[52:55], s8 offen offset:0 sc1
    buffer_load_dwordx4 v[184:187], v1, s[52:55], s5 offen offset:1024 sc1
    s_waitcnt vmcnt(12)
    v_mfma_f32_16x16x32_bf16 a[116:119], a[196:199], v[144:147], 0
    s_add_u32 s72, s4, 136192
    s_add_u32 s73, s4, 140288
    v_mfma_f32_16x16x32_bf16 a[120:123], a[200:203], v[144:147], 0
    s_add_u32 s69, s3, 0
    s_and_b32 s69, s69, 3
    v_mfma_f32_16x16x32_bf16 a[124:127], a[204:207], v[144:147], 0
    s_mul_i32 s69, s69, 12288
    s_add_u32 s69, s69, 81920
    v_mfma_f32_16x16x32_bf16 a[112:115], a[192:195], v[144:147], 0
    v_add_u32 v30, s69, v1
    buffer_load_dwordx4 v[188:191], v1, s[52:55], s8 offen offset:1024 sc1
    s_waitcnt vmcnt(10)
    v_mfma_f32_16x16x32_bf16 a[132:135], a[196:199], v[148:151], 0
    buffer_load_dwordx4 v[192:195], v1, s[52:55], s5 offen offset:2048 sc1
    s_add_u32 s69, s3, 1
    v_mfma_f32_16x16x32_bf16 a[136:139], a[200:203], v[148:151], 0
    buffer_load_dwordx4 v[196:199], v1, s[52:55], s8 offen offset:2048 sc1
    s_and_b32 s69, s69, 3
    v_mfma_f32_16x16x32_bf16 a[140:143], a[204:207], v[148:151], 0
    buffer_load_dwordx4 v[200:203], v1, s[52:55], s5 offen offset:3072 sc1
    s_mul_i32 s69, s69, 12288
    v_mfma_f32_16x16x32_bf16 a[128:131], a[192:195], v[148:151], 0
    s_add_u32 s69, s69, 81920
    s_barrier
    s_cmp_lg_u32 s3, 0
    s_cbranch_scc1 Lpub_44
    s_add_u32 s20, s66, 8
    v_mov_b32 v60, s20
    s_mov_b64 exec, 1
    s_cmp_eq_u32 s67, 1
    s_cbranch_scc1 Lpub_45
    buffer_store_dword v60, v41, s[52:55], s17 offen offset:224 sc1
    s_mov_b64 exec, -1
    s_branch Lpub_44
Lpub_45:
    buffer_store_dword v60, v41, s[52:55], s17 offen offset:224
    s_mov_b64 exec, -1
Lpub_44:
    buffer_load_dword v40, v39, s[52:55], s17 offen offset:192 sc1
    s_waitcnt vmcnt(13)
    v_mfma_f32_16x16x32_bf16 a[116:119], a[212:215], v[152:155], a[116:119]
    buffer_load_dwordx4 v[204:207], v1, s[52:55], s8 offen offset:3072 sc1
    v_add_u32 v27, s69, v1
    v_mfma_f32_16x16x32_bf16 a[120:123], a[216:219], v[152:155], a[120:123]
    s_add_u32 s69, s3, 2
    s_and_b32 s69, s69, 3
    v_mfma_f32_16x16x32_bf16 a[124:127], a[220:223], v[152:155], a[124:127]
    s_mul_i32 s69, s69, 12288
    s_add_u32 s69, s69, 86016
    v_mfma_f32_16x16x32_bf16 a[112:115], a[208:211], v[152:155], a[112:115]
    v_add_u32 v28, s69, v1
    s_waitcnt vmcnt(13)
    v_mfma_f32_16x16x32_bf16 a[132:135], a[212:215], v[156:159], a[132:135]
    s_add_u32 s69, s3, 3
    s_and_b32 s69, s69, 3
    v_mfma_f32_16x16x32_bf16 a[136:139], a[216:219], v[156:159], a[136:139]
    s_mul_i32 s69, s69, 12288
    s_add_u32 s69, s69, 90112
    v_mfma_f32_16x16x32_bf16 a[140:143], a[220:223], v[156:159], a[140:143]
    v_add_u32 v29, s69, v1
    v_and_b32 v26, 1, v24
    v_mfma_f32_16x16x32_bf16 a[128:131], a[208:211], v[156:159], a[128:131]
    buffer_load_dwordx4 v[144:147], v1, s[52:55], s6 offen offset:0 sc1
    s_waitcnt vmcnt(13)
    v_mfma_f32_16x16x32_bf16 a[116:119], a[228:231], v[160:163], a[116:119]
    v_lshlrev_b32 v2, 10, v23
    v_lshl_add_u32 v2, v26, 14, v2
    v_mfma_f32_16x16x32_bf16 a[120:123], a[232:235], v[160:163], a[120:123]
    v_lshrrev_b32 v26, 1, v24
    v_lshl_add_u32 v2, v26, 4, v2
    v_mfma_f32_16x16x32_bf16 a[124:127], a[236:239], v[160:163], a[124:127]
    s_add_u32 s74, s96, 32768
    s_waitcnt lgkmcnt(15)
    v_mfma_f32_16x16x32_bf16 a[112:115], a[224:227], v[160:163], a[112:115]
    buffer_load_dwordx4 v[148:151], v1, s[52:55], s9 offen offset:0 sc1
    s_waitcnt vmcnt(13)
    v_mfma_f32_16x16x32_bf16 a[132:135], a[228:231], v[164:167], a[132:135]
    v_lshlrev_b32 v136, 16, v138
    v_and_b32 v137, 0xffff0000, v138
    v_mfma_f32_16x16x32_bf16 a[136:139], a[232:235], v[164:167], a[136:139]
    v_lshlrev_b32 v138, 16, v139
    v_and_b32 v139, 0xffff0000, v139
    v_mfma_f32_16x16x32_bf16 a[140:143], a[236:239], v[164:167], a[140:143]
    buffer_load_dwordx4 v[152:155], v1, s[52:55], s6 offen offset:1024 sc1
    v_lshlrev_b32 v132, 16, v134
    v_mfma_f32_16x16x32_bf16 a[128:131], a[224:227], v[164:167], a[128:131]
    v_and_b32 v133, 0xffff0000, v134
    v_lshlrev_b32 v134, 16, v135
    v_and_b32 v135, 0xffff0000, v135
    v_fmac_f32 v112, v136, v132
    v_fmac_f32 v113, v137, v133
    v_fmac_f32 v114, v138, v134
    v_fmac_f32 v115, v139, v135
    v_fmac_f32 v116, v136, v132
    v_fmac_f32 v117, v137, v133
    v_fmac_f32 v118, v138, v134
    v_fmac_f32 v119, v139, v135
    v_fmac_f32 v120, v136, v132
    v_fmac_f32 v121, v137, v133
    v_fmac_f32 v122, v138, v134
    v_fmac_f32 v123, v139, v135
    v_fmac_f32 v124, v136, v132
    v_fmac_f32 v125, v137, v133
    v_fmac_f32 v126, v138, v134
    v_fmac_f32 v127, v139, v135
    s_waitcnt vmcnt(13)
    v_mfma_f32_16x16x32_bf16 a[116:119], a[244:247], v[168:171], a[116:119]
    buffer_load_dwordx4 v[156:159], v1, s[52:55], s9 offen offset:1024 sc1
    v_mfma_f32_16x16x32_bf16 a[120:123], a[248:251], v[168:171], a[120:123]
    v_mfma_f32_16x16x32_bf16 a[124:127], a[252:255], v[168:171], a[124:127]
    v_mfma_f32_16x16x32_bf16 a[112:115], a[240:243], v[168:171], a[112:115]
    s_waitcnt vmcnt(13)
    v_mfma_f32_16x16x32_bf16 a[132:135], a[244:247], v[172:175], a[132:135]
    buffer_load_dwordx4 v[160:163], v46, s[52:55], s6 offen offset:2048 sc1
    v_mfma_f32_16x16x32_bf16 a[136:139], a[248:251], v[172:175], a[136:139]
    v_mfma_f32_16x16x32_bf16 a[140:143], a[252:255], v[172:175], a[140:143]
    v_mfma_f32_16x16x32_bf16 a[128:131], a[240:243], v[172:175], a[128:131]
    s_waitcnt vmcnt(13)
    v_mfma_f32_16x16x32_bf16 a[116:119], a[4:7], v[176:179], a[116:119]
    buffer_load_dwordx4 v[164:167], v46, s[52:55], s9 offen offset:2048 sc1
    v_mfma_f32_16x16x32_bf16 a[120:123], a[8:11], v[176:179], a[120:123]
    v_mfma_f32_16x16x32_bf16 a[124:127], a[12:15], v[176:179], a[124:127]
    v_mfma_f32_16x16x32_bf16 a[112:115], a[0:3], v[176:179], a[112:115]
    s_waitcnt vmcnt(13)
    v_mfma_f32_16x16x32_bf16 a[132:135], a[4:7], v[180:183], a[132:135]
    v_mfma_f32_16x16x32_bf16 a[136:139], a[8:11], v[180:183], a[136:139]
    v_mfma_f32_16x16x32_bf16 a[140:143], a[12:15], v[180:183], a[140:143]
    v_mfma_f32_16x16x32_bf16 a[128:131], a[0:3], v[180:183], a[128:131]
    s_waitcnt vmcnt(12)
    v_mfma_f32_16x16x32_bf16 a[116:119], a[20:23], v[184:187], a[116:119]
    v_mfma_f32_16x16x32_bf16 a[120:123], a[24:27], v[184:187], a[120:123]
    v_mfma_f32_16x16x32_bf16 a[124:127], a[28:31], v[184:187], a[124:127]
    v_mfma_f32_16x16x32_bf16 a[112:115], a[16:19], v[184:187], a[112:115]
    s_add_u32 s20, s66, 7
    s_waitcnt vmcnt(7)
    v_cmp_ne_u32 s[28:29], s20, v40
    s_nop 0
    s_cmp_eq_u64 s[28:29], 0
    s_cbranch_scc1 Lwok_47
Lw_46:
    buffer_load_dword v40, v39, s[52:55], s17 offen offset:192 sc1
    s_waitcnt vmcnt(0)
    v_cmp_ne_u32 s[28:29], s20, v40
    s_nop 0
    s_cmp_eq_u64 s[28:29], 0
    s_cbranch_scc1 Lwok_47
    s_add_u32 s85, s85, 1
    s_cmp_lt_u32 s85, 400000
    s_cbranch_scc1 Lw_46
Lwok_47:
    buffer_load_dword v40, v39, s[52:55], s17 offen offset:224 sc1
    v_mfma_f32_16x16x32_bf16 a[132:135], a[20:23], v[188:191], a[132:135]
    buffer_load_dwordx4 v[168:171], v1, s[52:55], s10 offen offset:0 sc1
    v_mfma_f32_16x16x32_bf16 a[136:139], a[24:27], v[188:191], a[136:139]
    v_mfma_f32_16x16x32_bf16 a[140:143], a[28:31], v[188:191], a[140:143]
    v_mfma_f32_16x16x32_bf16 a[128:131], a[16:19], v[188:191], a[128:131]
    v_mfma_f32_16x16x32_bf16 a[116:119], a[36:39], v[192:195], a[116:119]
    buffer_load_dwordx4 v[172:175], v1, s[52:55], s10 offen offset:1024 sc1
    v_mfma_f32_16x16x32_bf16 a[120:123], a[40:43], v[192:195], a[120:123]
    v_mfma_f32_16x16x32_bf16 a[124:127], a[44:47], v[192:195], a[124:127]
    v_mfma_f32_16x16x32_bf16 a[112:115], a[32:35], v[192:195], a[112:115]
    v_mfma_f32_16x16x32_bf16 a[132:135], a[36:39], v[196:199], a[132:135]
    buffer_load_dwordx4 v[176:179], v1, s[52:55], s10 offen offset:2048 sc1
    v_mfma_f32_16x16x32_bf16 a[136:139], a[40:43], v[196:199], a[136:139]
    v_mfma_f32_16x16x32_bf16 a[140:143], a[44:47], v[196:199], a[140:143]
    v_mfma_f32_16x16x32_bf16 a[128:131], a[32:35], v[196:199], a[128:131]
    v_mfma_f32_16x16x32_bf16 a[116:119], a[52:55], v[200:203], a[116:119]
    buffer_load_dwordx4 v[180:183], v1, s[52:55], s10 offen offset:3072 sc1
    v_mfma_f32_16x16x32_bf16 a[120:123], a[56:59], v[200:203], a[120:123]
    v_mfma_f32_16x16x32_bf16 a[124:127], a[60:63], v[200:203], a[124:127]
    v_mfma_f32_16x16x32_bf16 a[112:115], a[48:51], v[200:203], a[112:115]
    s_waitcnt vmcnt(11)
    v_mfma_f32_16x16x32_bf16 a[132:135], a[52:55], v[204:207], a[132:135]
    v_mfma_f32_16x16x32_bf16 a[136:139], a[56:59], v[204:207], a[136:139]
    buffer_load_dwordx4 v[184:187], v1, s[52:55], s11 offen offset:0 sc1
    v_mfma_f32_16x16x32_bf16 a[140:143], a[60:63], v[204:207], a[140:143]
    v_mfma_f32_16x16x32_bf16 a[128:131], a[48:51], v[204:207], a[128:131]
    s_waitcnt vmcnt(11)
    v_mfma_f32_16x16x32_bf16 a[116:119], a[68:71], v[144:147], a[116:119]
    v_mfma_f32_16x16x32_bf16 a[120:123], a[72:75], v[144:147], a[120:123]
    buffer_load_dwordx4 v[188:191], v1, s[52:55], s11 offen offset:1024 sc1
    v_mfma_f32_16x16x32_bf16 a[124:127], a[76:79], v[144:147], a[124:127]
    v_mfma_f32_16x16x32_bf16 a[112:115], a[64:67], v[144:147], a[112:115]
    s_waitcnt vmcnt(11)
    v_mfma_f32_16x16x32_bf16 a[132:135], a[68:71], v[148:151], a[132:135]
    v_mfma_f32_16x16x32_bf16 a[136:139], a[72:75], v[148:151], a[136:139]
    buffer_load_dwordx4 v[192:195], v1, s[52:55], s11 offen offset:2048 sc1
    v_mfma_f32_16x16x32_bf16 a[140:143], a[76:79], v[148:151], a[140:143]
    v_mfma_f32_16x16x32_bf16 a[128:131], a[64:67], v[148:151], a[128:131]
    s_waitcnt vmcnt(11) lgkmcnt(8)
    v_mfma_f32_16x16x32_bf16 a[116:119], a[84:87], v[152:155], a[116:119]
    v_mfma_f32_16x16x32_bf16 a[120:123], a[88:91], v[152:155], a[120:123]
    buffer_load_dwordx4 v[196:199], v1, s[52:55], s11 offen offset:3072 sc1
    v_mfma_f32_16x16x32_bf16 a[124:127], a[92:95], v[152:155], a[124:127]
    v_mfma_f32_16x16x32_bf16 a[112:115], a[80:83], v[152:155], a[112:115]
    s_waitcnt vmcnt(11)
    v_mfma_f32_16x16x32_bf16 a[132:135], a[84:87], v[156:159], a[132:135]
    v_mfma_f32_16x16x32_bf16 a[136:139], a[88:91], v[156:159], a[136:139]
    buffer_load_dwordx4 v[200:203], v1, s[52:55], s12 offen offset:0 sc1
    v_mfma_f32_16x16x32_bf16 a[140:143], a[92:95], v[156:159], a[140:143]
    v_mfma_f32_16x16x32_bf16 a[128:131], a[80:83], v[156:159], a[128:131]
    s_waitcnt vmcnt(11) lgkmcnt(0)
    v_mfma_f32_16x16x32_bf16 a[116:119], a[100:103], v[160:163], a[116:119]
    v_mfma_f32_16x16x32_bf16 a[120:123], a[104:107], v[160:163], a[120:123]
    v_mfma_f32_16x16x32_bf16 a[124:127], a[108:111], v[160:163], a[124:127]
    v_mfma_f32_16x16x32_bf16 a[112:115], a[96:99], v[160:163], a[112:115]
    s_add_u32 s20, s66, 8
    s_waitcnt vmcnt(9)
    v_cmp_ne_u32 s[28:29], s20, v40
    s_nop 0
    s_cmp_eq_u64 s[28:29], 0
    s_cbranch_scc1 Lwok_49
Lw_48:
    buffer_load_dword v40, v39, s[52:55], s17 offen offset:224 sc1
    s_waitcnt vmcnt(0)
    v_cmp_ne_u32 s[28:29], s20, v40
    s_nop 0
    s_cmp_eq_u64 s[28:29], 0
    s_cbranch_scc1 Lwok_49
    s_add_u32 s85, s85, 1
    s_cmp_lt_u32 s85, 400000
    s_cbranch_scc1 Lw_48
Lwok_49:
    buffer_load_dwordx4 v[204:207], v1, s[52:55], s12 offen offset:1024 sc1
    buffer_load_dwordx4 v[144:147], v46, s[52:55], s12 offen offset:2048 sc1
    v_mfma_f32_16x16x32_bf16 a[132:135], a[100:103], v[164:167], a[132:135]
    v_mfma_f32_16x16x32_bf16 a[136:139], a[104:107], v[164:167], a[136:139]
    v_mfma_f32_16x16x32_bf16 a[140:143], a[108:111], v[164:167], a[140:143]
    v_mfma_f32_16x16x32_bf16 a[128:131], a[96:99], v[164:167], a[128:131]
    s_waitcnt vmcnt(10)
    v_mfma_f32_16x16x32_bf16 a[148:151], a[196:199], v[168:171], 0
    v_mfma_f32_16x16x32_bf16 a[152:155], a[200:203], v[168:171], 0
    v_mfma_f32_16x16x32_bf16 a[156:159], a[204:207], v[168:171], 0
    v_mfma_f32_16x16x32_bf16 a[144:147], a[192:195], v[168:171], 0
    buffer_load_dwordx4 v[148:151], v1, s[52:55], s13 offen offset:0 sc1
    s_waitcnt lgkmcnt(0)
    s_barrier
    s_waitcnt vmcnt(10)
    v_mfma_f32_16x16x32_bf16 a[148:151], a[212:215], v[172:175], a[148:151]
    buffer_load_dwordx4 v[152:155], v1, s[52:55], s13 offen offset:1024 sc1
    v_mfma_f32_16x16x32_bf16 a[152:155], a[216:219], v[172:175], a[152:155]
    v_mfma_f32_16x16x32_bf16 a[156:159], a[220:223], v[172:175], a[156:159]
    v_mfma_f32_16x16x32_bf16 a[144:147], a[208:211], v[172:175], a[144:147]
    s_waitcnt vmcnt(10)
    v_mfma_f32_16x16x32_bf16 a[148:151], a[228:231], v[176:179], a[148:151]
    buffer_load_dwordx4 v[156:159], v1, s[52:55], s13 offen offset:2048 sc1
    v_mfma_f32_16x16x32_bf16 a[152:155], a[232:235], v[176:179], a[152:155]
    ds_write_b128 v27, a[116:119] offset:0
    v_mfma_f32_16x16x32_bf16 a[156:159], a[236:239], v[176:179], a[156:159]
    ds_write_b128 v28, a[120:123] offset:0
    v_mfma_f32_16x16x32_bf16 a[144:147], a[224:227], v[176:179], a[144:147]
    ds_write_b128 v29, a[124:127] offset:0
    s_waitcnt vmcnt(10)
    v_mfma_f32_16x16x32_bf16 a[148:151], a[244:247], v[180:183], a[148:151]
    buffer_load_dwordx4 v[160:163], v1, s[52:55], s13 offen offset:3072 sc1
    v_mfma_f32_16x16x32_bf16 a[152:155], a[248:251], v[180:183], a[152:155]
    ds_write_b128 v27, a[132:135] offset:1024
    v_mfma_f32_16x16x32_bf16 a[156:159], a[252:255], v[180:183], a[156:159]
    ds_write_b128 v28, a[136:139] offset:1024
    v_mfma_f32_16x16x32_bf16 a[144:147], a[240:243], v[180:183], a[144:147]
    ds_write_b128 v29, a[140:143] offset:1024
    s_waitcnt vmcnt(10)
    v_mfma_f32_16x16x32_bf16 a[148:151], a[4:7], v[184:187], a[148:151]
    buffer_load_dwordx4 v[164:167], v1, s[52:55], s72 offen offset:0 sc1
    v_mfma_f32_16x16x32_bf16 a[152:155], a[8:11], v[184:187], a[152:155]
    v_mfma_f32_16x16x32_bf16 a[156:159], a[12:15], v[184:187], a[156:159]
    v_mfma_f32_16x16x32_bf16 a[144:147], a[0:3], v[184:187], a[144:147]
    s_waitcnt vmcnt(10)
    v_mfma_f32_16x16x32_bf16 a[148:151], a[20:23], v[188:191], a[148:151]
    buffer_load_dwordx4 v[168:171], v1, s[52:55], s72 offen offset:1024 sc1
    v_mfma_f32_16x16x32_bf16 a[152:155], a[24:27], v[188:191], a[152:155]
    v_mfma_f32_16x16x32_bf16 a[156:159], a[28:31], v[188:191], a[156:159]
    v_mfma_f32_16x16x32_bf16 a[144:147], a[16:19], v[188:191], a[144:147]
    s_waitcnt vmcnt(10)
    v_mfma_f32_16x16x32_bf16 a[148:151], a[36:39], v[192:195], a[148:151]
    v_mfma_f32_16x16x32_bf16 a[152:155], a[40:43], v[192:195], a[152:155]
    v_mfma_f32_16x16x32_bf16 a[156:159], a[44:47], v[192:195], a[156:159]
    v_mfma_f32_16x16x32_bf16 a[144:147], a[32:35], v[192:195], a[144:147]
    buffer_load_dwordx4 v[172:175], v1, s[52:55], s72 offen offset:2048 sc1
    buffer_load_dwordx4 v[176:179], v1, s[52:55], s72 offen offset:3072 sc1
    s_waitcnt vmcnt(11)
    v_mfma_f32_16x16x32_bf16 a[148:151], a[52:55], v[196:199], a[148:151]
    v_mfma_f32_16x16x32_bf16 a[152:155], a[56:59], v[196:199], a[152:155]
    v_mfma_f32_16x16x32_bf16 a[156:159], a[60:63], v[196:199], a[156:159]
    v_mfma_f32_16x16x32_bf16 a[144:147], a[48:51], v[196:199], a[144:147]
    s_waitcnt vmcnt(10)
    v_mfma_f32_16x16x32_bf16 a[148:151], a[68:71], v[200:203], a[148:151]
    v_mfma_f32_16x16x32_bf16 a[152:155], a[72:75], v[200:203], a[152:155]
    v_mfma_f32_16x16x32_bf16 a[156:159], a[76:79], v[200:203], a[156:159]
    v_mfma_f32_16x16x32_bf16 a[144:147], a[64:67], v[200:203], a[144:147]
    buffer_load_dwordx4 v[180:183], v1, s[52:55], s73 offen offset:0 sc1
    s_waitcnt vmcnt(10)
    v_mfma_f32_16x16x32_bf16 a[148:151], a[84:87], v[204:207], a[148:151]
    buffer_load_dwordx4 v[184:187], v1, s[52:55], s73 offen offset:1024 sc1
    v_mfma_f32_16x16x32_bf16 a[152:155], a[88:91], v[204:207], a[152:155]
    v_mfma_f32_16x16x32_bf16 a[156:159], a[92:95], v[204:207], a[156:159]
    v_mfma_f32_16x16x32_bf16 a[144:147], a[80:83], v[204:207], a[144:147]
    s_waitcnt vmcnt(10)
    v_mfma_f32_16x16x32_bf16 a[148:151], a[100:103], v[144:147], a[148:151]
    buffer_load_dwordx4 v[188:191], v46, s[52:55], s73 offen offset:2048 sc1
    v_mfma_f32_16x16x32_bf16 a[152:155], a[104:107], v[144:147], a[152:155]
    v_mfma_f32_16x16x32_bf16 a[156:159], a[108:111], v[144:147], a[156:159]
    v_mfma_f32_16x16x32_bf16 a[144:147], a[96:99], v[144:147], a[144:147]
    s_waitcnt vmcnt(10)
    v_mfma_f32_16x16x32_bf16 a[164:167], a[196:199], v[148:151], 0
    v_mfma_f32_16x16x32_bf16 a[168:171], a[200:203], v[148:151], 0
    v_mfma_f32_16x16x32_bf16 a[172:175], a[204:207], v[148:151], 0
    v_mfma_f32_16x16x32_bf16 a[160:163], a[192:195], v[148:151], 0
    s_waitcnt vmcnt(9)
    v_mfma_f32_16x16x32_bf16 a[164:167], a[212:215], v[152:155], a[164:167]
    v_mfma_f32_16x16x32_bf16 a[168:171], a[216:219], v[152:155], a[168:171]
    v_mfma_f32_16x16x32_bf16 a[172:175], a[220:223], v[152:155], a[172:175]
    v_mfma_f32_16x16x32_bf16 a[160:163], a[208:211], v[152:155], a[160:163]
    s_waitcnt vmcnt(8)
    v_mfma_f32_16x16x32_bf16 a[164:167], a[228:231], v[156:159], a[164:167]
    ds_write_b128 v27, a[148:151] offset:2048
    v_mfma_f32_16x16x32_bf16 a[168:171], a[232:235], v[156:159], a[168:171]
    ds_write_b128 v28, a[152:155] offset:2048
    v_mfma_f32_16x16x32_bf16 a[172:175], a[236:239], v[156:159], a[172:175]
    ds_write_b128 v29, a[156:159] offset:2048
    v_mfma_f32_16x16x32_bf16 a[160:163], a[224:227], v[156:159], a[160:163]
    s_waitcnt vmcnt(7)
    v_mfma_f32_16x16x32_bf16 a[164:167], a[244:247], v[160:163], a[164:167]
    v_mfma_f32_16x16x32_bf16 a[168:171], a[248:251], v[160:163], a[168:171]
    v_mfma_f32_16x16x32_bf16 a[172:175], a[252:255], v[160:163], a[172:175]
    v_mfma_f32_16x16x32_bf16 a[160:163], a[240:243], v[160:163], a[160:163]
    s_waitcnt vmcnt(6)
    v_mfma_f32_16x16x32_bf16 a[164:167], a[4:7], v[164:167], a[164:167]
    v_mfma_f32_16x16x32_bf16 a[168:171], a[8:11], v[164:167], a[168:171]
    v_mfma_f32_16x16x32_bf16 a[172:175], a[12:15], v[164:167], a[172:175]
    v_mfma_f32_16x16x32_bf16 a[160:163], a[0:3], v[164:167], a[160:163]
    s_waitcnt vmcnt(5)
    v_mfma_f32_16x16x32_bf16 a[164:167], a[20:23], v[168:171], a[164:167]
    v_mfma_f32_16x16x32_bf16 a[168:171], a[24:27], v[168:171], a[168:171]
    v_mfma_f32_16x16x32_bf16 a[172:175], a[28:31], v[168:171], a[172:175]
    v_mfma_f32_16x16x32_bf16 a[160:163], a[16:19], v[168:171], a[160:163]
    s_waitcnt vmcnt(4)
    v_mfma_f32_16x16x32_bf16 a[164:167], a[36:39], v[172:175], a[164:167]
    v_mfma_f32_16x16x32_bf16 a[168:171], a[40:43], v[172:175], a[168:171]
    v_mfma_f32_16x16x32_bf16 a[172:175], a[44:47], v[172:175], a[172:175]
    v_mfma_f32_16x16x32_bf16 a[160:163], a[32:35], v[172:175], a[160:163]
    s_waitcnt lgkmcnt(0)
    s_barrier
    s_waitcnt vmcnt(3)
    v_mfma_f32_16x16x32_bf16 a[164:167], a[52:55], v[176:179], a[164:167]
    ds_read_b128 v[64:67], v30 offset:0
    ds_read_b128 v[68:71], v30 offset:4096
    ds_read_b128 v[72:75], v30 offset:8192
    s_waitcnt lgkmcnt(0)
    v_mfma_f32_16x16x32_bf16 a[168:171], a[56:59], v[176:179], a[168:171]
    ds_read_b128 v[76:79], v30 offset:1024
    v_accvgpr_read_b32 v208, a112
    v_mfma_f32_16x16x32_bf16 a[172:175], a[60:63], v[176:179], a[172:175]
    ds_read_b128 v[80:83], v30 offset:5120
    v_accvgpr_read_b32 v209, a113
    v_mfma_f32_16x16x32_bf16 a[160:163], a[48:51], v[176:179], a[160:163]
    ds_read_b128 v[84:87], v30 offset:9216
    s_waitcnt vmcnt(2)
    v_mfma_f32_16x16x32_bf16 a[164:167], a[68:71], v[180:183], a[164:167]
    ds_read_b128 v[88:91], v30 offset:2048
    v_accvgpr_read_b32 v210, a114
    v_mfma_f32_16x16x32_bf16 a[168:171], a[72:75], v[180:183], a[168:171]
    ds_read_b128 v[92:95], v30 offset:6144
    v_accvgpr_read_b32 v211, a115
    v_mfma_f32_16x16x32_bf16 a[172:175], a[76:79], v[180:183], a[172:175]
    ds_read_b128 v[96:99], v30 offset:10240
    v_add_f32 v64, v64, v68
    v_mfma_f32_16x16x32_bf16 a[160:163], a[64:67], v[180:183], a[160:163]
    v_add_f32 v65, v65, v69
    s_waitcnt vmcnt(1)
    v_mfma_f32_16x16x32_bf16 a[164:167], a[84:87], v[184:187], a[164:167]
    v_add_f32 v66, v66, v70
    v_add_f32 v67, v67, v71
    v_mfma_f32_16x16x32_bf16 a[168:171], a[88:91], v[184:187], a[168:171]
    v_add_f32 v72, v72, v208
    v_add_f32 v73, v73, v209
    v_mfma_f32_16x16x32_bf16 a[172:175], a[92:95], v[184:187], a[172:175]
    v_add_f32 v74, v74, v210
    v_add_f32 v75, v75, v211
    v_mfma_f32_16x16x32_bf16 a[160:163], a[80:83], v[184:187], a[160:163]
    v_add_f32 v64, v64, v72
    s_waitcnt vmcnt(0)
    v_mfma_f32_16x16x32_bf16 a[164:167], a[100:103], v[188:191], a[164:167]
    v_add_f32 v65, v65, v73
    v_add_f32 v66, v66, v74
    v_mfma_f32_16x16x32_bf16 a[168:171], a[104:107], v[188:191], a[168:171]
    v_add_f32 v67, v67, v75
    v_fma_f32 v64, v136, v64, v112
    v_mfma_f32_16x16x32_bf16 a[172:175], a[108:111], v[188:191], a[172:175]
    v_fma_f32 v65, v137, v65, v113
    v_fma_f32 v66, v138, v66, v114
    v_mfma_f32_16x16x32_bf16 a[160:163], a[96:99], v[188:191], a[160:163]
    v_fma_f32 v67, v139, v67, v115
    ds_write_b128 v27, a[164:167] offset:3072
    ds_write_b128 v28, a[168:171] offset:3072
    s_nop 1
    ds_write_b128 v29, a[172:175] offset:3072
    v_cvt_pk_bf16_f32 v224, v64, v65
    v_cvt_pk_bf16_f32 v225, v66, v67
    s_waitcnt lgkmcnt(6)
    v_accvgpr_read_b32 v212, a128
    v_accvgpr_read_b32 v213, a129
    v_accvgpr_read_b32 v214, a130
    v_accvgpr_read_b32 v215, a131
    v_add_f32 v76, v76, v80
    v_add_f32 v77, v77, v81
    v_add_f32 v78, v78, v82
    v_add_f32 v79, v79, v83
    v_add_f32 v84, v84, v212
    v_add_f32 v85, v85, v213
    v_add_f32 v86, v86, v214
    v_add_f32 v87, v87, v215
    v_add_f32 v76, v76, v84
    v_add_f32 v77, v77, v85
    v_add_f32 v78, v78, v86
    v_add_f32 v79, v79, v87
    v_fma_f32 v76, v136, v76, v116
    v_fma_f32 v77, v137, v77, v117
    v_fma_f32 v78, v138, v78, v118
    v_fma_f32 v79, v139, v79, v119
    v_cvt_pk_bf16_f32 v226, v76, v77
    v_cvt_pk_bf16_f32 v227, v78, v79
    s_nop 0
    v_permlane16_swap_b32 v224, v226
    v_permlane16_swap_b32 v225, v227
    buffer_store_dwordx4 v[224:227], v2, s[56:59], s96 offen
    s_waitcnt lgkmcnt(3)
    v_accvgpr_read_b32 v216, a144
    v_accvgpr_read_b32 v217, a145
    v_accvgpr_read_b32 v218, a146
    v_accvgpr_read_b32 v219, a147
    v_add_f32 v88, v88, v92
    v_add_f32 v89, v89, v93
    v_add_f32 v90, v90, v94
    v_add_f32 v91, v91, v95
    v_add_f32 v96, v96, v216
    v_add_f32 v97, v97, v217
    v_add_f32 v98, v98, v218
    v_add_f32 v99, v99, v219
    v_add_f32 v88, v88, v96
    v_add_f32 v89, v89, v97
    v_add_f32 v90, v90, v98
    v_add_f32 v91, v91, v99
    v_fma_f32 v88, v136, v88, v120
    v_fma_f32 v89, v137, v89, v121
    v_fma_f32 v90, v138, v90, v122
    v_fma_f32 v91, v139, v91, v123
    v_cvt_pk_bf16_f32 v228, v88, v89
    v_cvt_pk_bf16_f32 v229, v90, v91
    s_waitcnt lgkmcnt(0)
    s_barrier
    ds_read_b128 v[100:103], v30 offset:3072
    ds_read_b128 v[104:107], v30 offset:7168
    ds_read_b128 v[108:111], v30 offset:11264
    s_waitcnt lgkmcnt(0)
    v_accvgpr_read_b32 v220, a160
    v_accvgpr_read_b32 v221, a161
    v_accvgpr_read_b32 v222, a162
    v_accvgpr_read_b32 v223, a163
    v_pk_add_f32 v[100:101], v[100:101], v[104:105]
    v_pk_add_f32 v[102:103], v[102:103], v[106:107]
    v_pk_add_f32 v[108:109], v[108:109], v[220:221]
    v_pk_add_f32 v[110:111], v[110:111], v[222:223]
    v_pk_add_f32 v[100:101], v[100:101], v[108:109]
    v_pk_add_f32 v[102:103], v[102:103], v[110:111]
    v_pk_fma_f32 v[100:101], v[136:137], v[100:101], v[124:125]
    v_pk_fma_f32 v[102:103], v[138:139], v[102:103], v[126:127]
    v_cvt_pk_bf16_f32 v230, v100, v101
    v_cvt_pk_bf16_f32 v231, v102, v103
    s_nop 0
    v_permlane16_swap_b32 v228, v230
    v_permlane16_swap_b32 v229, v231
    buffer_store_dwordx4 v[228:231], v2, s[56:59], s74 offen
    s_endpgm
.fill 2048, 4, 0xbf800000
.section .rodata,"a"
.p2align 6
.amdhsa_kernel adaLN_cond__sliding_local_dilated__mixer_channel_mlp__prompt_kernel
  .amdhsa_next_free_vgpr 512
  .amdhsa_next_free_sgpr 102
  .amdhsa_accum_offset 256
  .amdhsa_group_segment_fixed_size 0
  .amdhsa_kernarg_size 104
  .amdhsa_user_sgpr_count 2
  .amdhsa_user_sgpr_kernarg_segment_ptr 1
  .amdhsa_system_sgpr_workgroup_id_x 1
.end_amdhsa_kernel
```
